```python
import torch

def _softmax(x, axis=-1):
    return torch.softmax(x, dim=axis)
def _gelu(x):
    return torch.nn.functional.gelu(x, approximate="tanh")
def _silu(x):
    return torch.nn.functional.silu(x)
def _sigmoid(x):
    return torch.sigmoid(x)
def _layernorm(x, axis=-1, eps=1e-5):
    m = x.mean(dim=axis, keepdim=True)
    v = x.var(dim=axis, keepdim=True, unbiased=False)
    return (x - m) / torch.sqrt(v + eps)
def _scatter_add(tgt, idx, src, axis=0):
    return tgt.clone().index_add_(axis, idx, src)
def _segment_sum(src, seg, n):
    out = torch.zeros((n,) + src.shape[1:], dtype=src.dtype)
    return out.index_add_(0, seg, src)
def _pad(x, pw):
    flat = tuple(v for pair in reversed(pw) for v in pair)
    return torch.nn.functional.pad(x, flat)

kernel_name = 'sequential_preLN__gqa_block_cached__geglu_ffn__decode'

def setup_inputs():

    _w = (lambda a: (lambda t: t.to(torch.bfloat16) if t.is_floating_point() else t)(torch.as_tensor(a)))
    def _A_setup():
        B, Sq, D = 8, 1, 576
        Hq, Hkv, Sk, Dh = 32, 16, 4096, 128
        assert Hq % Hkv == 0, (Hq, Hkv)
        return {
            "x": _w((lambda *s: torch.randn(*s, dtype=torch.bfloat16) * 0.05)(B, Sq, D)),
            "k_cache": _w((lambda *s: torch.randn(*s, dtype=torch.bfloat16) * 3.2)(B, Hkv, Sk, Dh)),
            "v_cache": _w((lambda *s: torch.randn(*s, dtype=torch.bfloat16) * 0.4)(B, Hkv, Sk, Dh)),
            "wq": _w((lambda *s: torch.randn(*s, dtype=torch.bfloat16) * 3.2)(D, Hq * Dh) * (D ** -0.5)),
            "wo": _w((lambda *s: torch.randn(*s, dtype=torch.bfloat16) * 0.4)(Hq * Dh, D) * ((Hq * Dh) ** -0.5)),
        }
    _A_in = _A_setup()

    def _B_setup():
        B, S, D, F = 8, 1, 576, 4608
        return {
            "x": _w((lambda *s: torch.randn(*s, dtype=torch.bfloat16) * 0.05)(B, S, D)),
            "w_gate": _w((lambda *s: torch.randn(*s, dtype=torch.bfloat16) * 0.05)(D, F)),
            "w_up": _w((lambda *s: torch.randn(*s, dtype=torch.bfloat16) * 0.05)(D, F)),
            "w_down": _w((lambda *s: torch.randn(*s, dtype=torch.bfloat16) * 0.05)(F, D)),
        }
    _B_in = _B_setup()

    return {
        "A_x": _A_in["x"],
        "A_k_cache": _A_in["k_cache"],
        "A_v_cache": _A_in["v_cache"],
        "A_wq": _A_in["wq"],
        "A_wo": _A_in["wo"],
        "B_x": _B_in["x"],
        "B_w_gate": _B_in["w_gate"],
        "B_w_up": _B_in["w_up"],
        "B_w_down": _B_in["w_down"],
    }

def reference(A_x, A_k_cache, A_v_cache, A_wq, A_wo, B_x, B_w_gate, B_w_up, B_w_down):
    def _A_ref(x, k_cache, v_cache, wq, wo):
        B, Sq, D = x.shape
        Hq, Dh = 32, 128
        Hkv = k_cache.shape[1]
        rep = Hq // Hkv
        q = (lambda x, *d: x.permute(*d))((x @ wq).reshape(B, Sq, Hq, Dh), 0, 2, 1, 3)
        k = (lambda x, n, axis: torch.repeat_interleave(x, n, dim=axis))(k_cache, rep, axis=1)
        v = (lambda x, n, axis: torch.repeat_interleave(x, n, dim=axis))(v_cache, rep, axis=1)
        scores = torch.einsum("bhqd,bhkd->bhqk", q, k) * (Dh ** -0.5)
        p = _softmax(scores, axis=-1)
        o = torch.einsum("bhqk,bhkd->bhqd", p, v)
        return (lambda x, *d: x.permute(*d))(o, 0, 2, 1, 3).reshape(B, Sq, Hq * Dh) @ wo

    def _B_ref(x, w_gate, w_up, w_down):
        return (_gelu(x @ w_gate) * (x @ w_up)) @ w_down

    x = A_x
    h = x + _A_ref(_layernorm(x, axis=-1), A_k_cache, A_v_cache, A_wq, A_wo)
    h2 = h + _B_ref(_layernorm(h, axis=-1), B_w_gate, B_w_up, B_w_down)
    return h2
```

```asm
; @launch grid=(256,1,1) block=(1024,1,1) lds=102912
.amdgcn_target "amdgcn-amd-amdhsa--gfx950"
.text
.globl sequential_preLN__gqa_block_cached__geglu_ffn__decode_kernel
.p2align 8
.type sequential_preLN__gqa_block_cached__geglu_ffn__decode_kernel,@function
sequential_preLN__gqa_block_cached__geglu_ffn__decode_kernel:
    s_cmp_ge_u32 s2, 256
    s_cbranch_scc1 L_end
    s_load_dwordx16 s[4:19], s[0:1], 0
    s_load_dwordx8 s[20:27], s[0:1], 64
    v_and_b32 v1, 63, v0
    v_lshrrev_b32 v4, 6, v0
    s_nop 0
    v_readfirstlane_b32 s52, v4
    s_lshr_b32 s55, s2, 7
    s_and_b32 s60, s2, 127
    s_xor_b32 s60, s60, s55
    s_and_b32 s53, s60, 15
    s_lshr_b32 s54, s60, 4
    s_lshl_b32 s56, s53, 4
    s_lshl_b32 s57, s54, 1
    s_add_u32 s56, s56, s57
    s_add_u32 s56, s56, s55
    s_mov_b32 s65, 0xffff0000
    s_mov_b32 s66, 0x3fb8aa3b
    s_mov_b32 s61, s52
    s_add_u32 s62, s52, 16
    s_xor_b32 s57, s60, 0x81
    s_add_u32 s50, s57, 8
    s_cmp_lt_u32 s57, 64
    s_cselect_b32 s50, s57, s50
    s_sub_u32 s51, s57, 64
    s_cmp_lt_u32 s57, 128
    s_cselect_b32 s50, s50, s51
    s_cmp_lt_u32 s57, 136
    s_cselect_b32 s57, s50, s57
    s_cmp_lt_u32 s57, 136
    s_cselect_b32 s58, 11, 0
    s_cmp_lt_u32 s57, 72
    s_cselect_b32 s58, 4, s58
    s_cmp_eq_u32 s57, 190
    s_cselect_b32 s58, 3, s58
    s_add_u32 s50, s60, 8
    s_cmp_lt_u32 s60, 64
    s_cselect_b32 s50, s60, s50
    s_sub_u32 s51, s60, 64
    s_cmp_lt_u32 s60, 128
    s_cselect_b32 s50, s50, s51
    s_cmp_lt_u32 s60, 136
    s_cselect_b32 s64, s50, s60
    s_cmp_lt_u32 s64, 136
    s_cselect_b32 s59, 11, 0
    s_cmp_lt_u32 s64, 72
    s_cselect_b32 s59, 4, s59
    s_cmp_eq_u32 s64, 190
    s_cselect_b32 s59, 3, s59
    s_cmp_eq_u32 s55, 0
    s_cselect_b32 s2, s64, s57
    s_add_u32 s58, s58, 128
    s_sub_u32 s58, s58, s59
    s_sub_u32 s59, 256, s58
    s_cmp_eq_u32 s55, 0
    s_cselect_b32 s48, s58, s59
    s_cselect_b32 s50, 0, s58
    v_bfe_u32 v4, v1, 2, 2
    v_lshlrev_b32 v2, 8, v4
    v_lshrrev_b32 v5, 4, v1
    v_lshl_add_u32 v2, v5, 6, v2
    v_and_b32 v4, 3, v1
    v_lshl_add_u32 v2, v4, 4, v2
    v_lshlrev_b32 v3, 4, v1
    v_mov_b32 v120, 0
    v_mov_b32 v121, 1
    s_waitcnt lgkmcnt(0)
    s_load_dword s67, s[26:27], 0xa2800
    s_lshl_b32 s57, s60, 20
    s_lshl_b32 s58, s50, 12
    s_add_u32 s57, s57, s58
    s_lshl_b32 s59, s48, 12
    s_add_u32 s28, s6, s57
    s_addc_u32 s29, s7, 0
    s_mov_b32 s30, s59
    s_mov_b32 s31, 0x00020000
    s_add_u32 s32, s8, s57
    s_addc_u32 s33, s9, 0
    s_mov_b32 s34, s59
    s_mov_b32 s35, 0x00020000
    s_mov_b32 s36, s26
    s_mov_b32 s37, s27
    s_mov_b32 s38, 0x200000
    s_mov_b32 s39, 0x00020000
    s_sub_u32 s84, s2, 72
    s_cmp_lt_u32 s84, 64
    s_cbranch_scc1 L_qprod
    s_cmp_lt_u32 s52, 14
    s_cbranch_scc1 L_hk0_done
    s_cmp_eq_u32 s52, 14
    s_cbranch_scc1 L_hk0_clr
    v_mov_b32 v16, 32
    ds_write_b32 v120, v16 offset:0
    s_branch L_hk0_done
L_hk0_clr:
    v_mov_b32 v16, -1
    v_mov_b32 v17, -1
    v_mov_b32 v18, -1
    v_mov_b32 v19, -1
    s_lshl_b32 s58, s56, 10
    s_add_u32 s58, s58, 0xd0000
    s_cmp_lt_u32 s56, 72
    s_cselect_b32 s58, s58, 0x200000
    buffer_store_dwordx4 v[16:19], v3, s[36:39], s58 offen sc1
    s_nop 1
L_hk0_done:
    s_cmp_ge_u32 s2, 72
    s_cbranch_scc1 L_np_a
    s_and_b32 s57, s2, 7
    s_lshr_b32 s58, s2, 3
    s_mul_i32 s57, s57, 589824
    s_lshl_b32 s58, s58, 7
    s_add_u32 s57, s57, s58
    s_add_u32 s44, s12, s57
    s_addc_u32 s45, s13, 0
    s_mov_b32 s46, 0x8fc00
    s_mov_b32 s47, 0x00020000
    s_lshl_b32 s59, s52, 5
    v_lshrrev_b32 v4, 3, v1
    v_add_u32 v4, s59, v4
    v_mul_u32_u24 v4, 1152, v4
    v_and_b32 v5, 7, v1
    v_lshl_add_u32 v4, v5, 4, v4
    s_lshl_b32 s57, s59, 7
    s_add_u32 s57, s57, 29184
    s_mov_b32 s58, 0
    s_mov_b32 m0, s57
    s_nop 0
    buffer_load_dwordx4 v4, s[44:47], s58 offen nt lds
    s_add_u32 s57, s57, 1024
    s_add_u32 s58, s58, 9216
    s_mov_b32 m0, s57
    s_nop 0
    buffer_load_dwordx4 v4, s[44:47], s58 offen nt lds
    s_add_u32 s57, s57, 1024
    s_add_u32 s58, s58, 9216
    s_mov_b32 m0, s57
    s_nop 0
    buffer_load_dwordx4 v4, s[44:47], s58 offen nt lds
    s_add_u32 s57, s57, 1024
    s_add_u32 s58, s58, 9216
    s_mov_b32 m0, s57
    s_nop 0
    buffer_load_dwordx4 v4, s[44:47], s58 offen nt lds
    s_branch L_np_ring
L_np_a:
    s_cmp_lg_u32 s2, 190
    s_cbranch_scc1 L_np_ring
    s_cmp_ge_u32 s52, 12
    s_cbranch_scc1 L_np_ring
    v_mov_b32 v16, 0
    v_mov_b32 v17, 0
    v_mov_b32 v18, 0
    v_mov_b32 v19, 0
    s_mul_i32 s58, s52, 6144
    s_add_u32 s58, s58, 0xb0000
    buffer_store_dwordx4 v[16:19], v3, s[36:39], s58 offen offset:0 sc1
    buffer_store_dwordx4 v[16:19], v3, s[36:39], s58 offen offset:1024 sc1
    buffer_store_dwordx4 v[16:19], v3, s[36:39], s58 offen offset:2048 sc1
    buffer_store_dwordx4 v[16:19], v3, s[36:39], s58 offen offset:3072 sc1
    s_add_u32 s58, s58, 4096
    buffer_store_dwordx4 v[16:19], v3, s[36:39], s58 offen offset:0 sc1
    buffer_store_dwordx4 v[16:19], v3, s[36:39], s58 offen offset:1024 sc1
    s_nop 1
L_np_ring:
    s_lshl_b32 s64, s61, 12
    s_waitcnt vmcnt(3)
    buffer_load_dwordx4 v[56:59], v2, s[28:31], s64 offen offset:0 nt
    s_waitcnt vmcnt(3)
    buffer_load_dwordx4 v[60:63], v2, s[28:31], s64 offen offset:1024 nt
    s_waitcnt vmcnt(3)
    buffer_load_dwordx4 v[64:67], v2, s[28:31], s64 offen offset:2048 nt
    s_waitcnt vmcnt(3)
    buffer_load_dwordx4 v[68:71], v2, s[28:31], s64 offen offset:3072 nt
    s_waitcnt vmcnt(3)
    buffer_load_dwordx4 v[72:75], v3, s[32:35], s64 offen offset:0 nt
    s_waitcnt vmcnt(3)
    buffer_load_dwordx4 v[76:79], v3, s[32:35], s64 offen offset:1024 nt
    s_waitcnt vmcnt(3)
    buffer_load_dwordx4 v[80:83], v3, s[32:35], s64 offen offset:2048 nt
    s_waitcnt vmcnt(3)
    buffer_load_dwordx4 v[84:87], v3, s[32:35], s64 offen offset:3072 nt
    s_lshl_b32 s64, s62, 12
    s_waitcnt vmcnt(3)
    buffer_load_dwordx4 v[88:91], v2, s[28:31], s64 offen offset:0 nt
    s_waitcnt vmcnt(3)
    buffer_load_dwordx4 v[92:95], v2, s[28:31], s64 offen offset:1024 nt
    s_waitcnt vmcnt(3)
    buffer_load_dwordx4 v[96:99], v2, s[28:31], s64 offen offset:2048 nt
    s_waitcnt vmcnt(3)
    buffer_load_dwordx4 v[100:103], v2, s[28:31], s64 offen offset:3072 nt
    s_waitcnt vmcnt(3)
    buffer_load_dwordx4 v[104:107], v3, s[32:35], s64 offen offset:0 nt
    s_waitcnt vmcnt(3)
    buffer_load_dwordx4 v[108:111], v3, s[32:35], s64 offen offset:1024 nt
    s_waitcnt vmcnt(3)
    buffer_load_dwordx4 v[112:115], v3, s[32:35], s64 offen offset:2048 nt
    s_waitcnt vmcnt(3)
    buffer_load_dwordx4 v[116:119], v3, s[32:35], s64 offen offset:3072 nt
    s_waitcnt vmcnt(16)
    v_and_b32 v4, 1, v1
    v_lshlrev_b32 v4, 4, v4
    v_mov_b32 v6, 0xffff
    v_lshlrev_b32 v6, v4, v6
    v_bfe_u32 v4, v1, 1, 2
    v_cmp_eq_u32 vcc, 0, v4
    s_nop 1
    v_cndmask_b32 v8, 0, v6, vcc
    v_cmp_eq_u32 vcc, 1, v4
    s_nop 1
    v_cndmask_b32 v9, 0, v6, vcc
    v_cmp_eq_u32 vcc, 2, v4
    s_nop 1
    v_cndmask_b32 v10, 0, v6, vcc
    v_cmp_eq_u32 vcc, 3, v4
    s_nop 1
    v_cndmask_b32 v11, 0, v6, vcc
    s_waitcnt lgkmcnt(0)
    s_add_u32 s67, s67, 1
    s_mul_i32 s3, s67, 0x9E3779B1
    s_branch L_gather
L_qprod:
    s_cmp_ge_u32 s52, 8
    s_cbranch_scc1 L_qp_hi
    s_mul_i32 s57, s52, 1152
    s_add_u32 s40, s4, s57
    s_addc_u32 s41, s5, 0
    s_mov_b32 s42, 0x480
    s_mov_b32 s43, 0x00020000
    v_lshlrev_b32 v4, 1, v1
    buffer_load_ushort v16, v4, s[40:43], 0 offen offset:0
    buffer_load_ushort v17, v4, s[40:43], 0 offen offset:128
    buffer_load_ushort v18, v4, s[40:43], 0 offen offset:256
    buffer_load_ushort v19, v4, s[40:43], 0 offen offset:384
    buffer_load_ushort v20, v4, s[40:43], 0 offen offset:512
    buffer_load_ushort v21, v4, s[40:43], 0 offen offset:640
    buffer_load_ushort v22, v4, s[40:43], 0 offen offset:768
    buffer_load_ushort v23, v4, s[40:43], 0 offen offset:896
    buffer_load_ushort v24, v4, s[40:43], 0 offen offset:1024
    v_and_b32 v4, 1, v1
    v_lshlrev_b32 v4, 4, v4
    v_mov_b32 v6, 0xffff
    v_lshlrev_b32 v6, v4, v6
    v_bfe_u32 v4, v1, 1, 2
    v_cmp_eq_u32 vcc, 0, v4
    s_nop 1
    v_cndmask_b32 v8, 0, v6, vcc
    v_cmp_eq_u32 vcc, 1, v4
    s_nop 1
    v_cndmask_b32 v9, 0, v6, vcc
    v_cmp_eq_u32 vcc, 2, v4
    s_nop 1
    v_cndmask_b32 v10, 0, v6, vcc
    v_cmp_eq_u32 vcc, 3, v4
    s_nop 1
    v_cndmask_b32 v11, 0, v6, vcc
    s_mul_i32 s57, s52, 1216
    v_lshlrev_b32 v4, 1, v1
    v_add_u32 v4, s57, v4
    s_waitcnt vmcnt(0)
    v_lshlrev_b32 v16, 16, v16
    v_lshlrev_b32 v17, 16, v17
    v_lshlrev_b32 v18, 16, v18
    v_lshlrev_b32 v19, 16, v19
    v_lshlrev_b32 v20, 16, v20
    v_lshlrev_b32 v21, 16, v21
    v_lshlrev_b32 v22, 16, v22
    v_lshlrev_b32 v23, 16, v23
    v_lshlrev_b32 v24, 16, v24
    v_add_f32 v26, v16, v17
    v_add_f32 v26, v26, v18
    v_add_f32 v26, v26, v19
    v_add_f32 v26, v26, v20
    v_add_f32 v26, v26, v21
    v_add_f32 v26, v26, v22
    v_add_f32 v26, v26, v23
    v_add_f32 v26, v26, v24
    s_nop 1
    v_add_f32_dpp v26, v26, v26 quad_perm:[1,0,3,2] row_mask:0xf bank_mask:0xf
    s_nop 1
    v_add_f32_dpp v26, v26, v26 quad_perm:[2,3,0,1] row_mask:0xf bank_mask:0xf
    s_nop 1
    v_add_f32_dpp v26, v26, v26 row_half_mirror row_mask:0xf bank_mask:0xf
    s_nop 1
    v_add_f32_dpp v26, v26, v26 row_mirror row_mask:0xf bank_mask:0xf
    v_mov_b32 v27, v26
    s_nop 1
    v_permlane16_swap_b32 v26, v27
    v_add_f32 v26, v26, v27
    v_mov_b32 v27, v26
    s_nop 1
    v_permlane32_swap_b32 v26, v27
    v_add_f32 v26, v26, v27
    v_mul_f32 v28, 0x3ae38e39, v26
    v_sub_f32 v27, v16, v28
    v_mul_f32 v26, v27, v27
    v_sub_f32 v27, v17, v28
    v_fmac_f32 v26, v27, v27
    v_sub_f32 v27, v18, v28
    v_fmac_f32 v26, v27, v27
    v_sub_f32 v27, v19, v28
    v_fmac_f32 v26, v27, v27
    v_sub_f32 v27, v20, v28
    v_fmac_f32 v26, v27, v27
    v_sub_f32 v27, v21, v28
    v_fmac_f32 v26, v27, v27
    v_sub_f32 v27, v22, v28
    v_fmac_f32 v26, v27, v27
    v_sub_f32 v27, v23, v28
    v_fmac_f32 v26, v27, v27
    v_sub_f32 v27, v24, v28
    v_fmac_f32 v26, v27, v27
    s_nop 1
    v_add_f32_dpp v26, v26, v26 quad_perm:[1,0,3,2] row_mask:0xf bank_mask:0xf
    s_nop 1
    v_add_f32_dpp v26, v26, v26 quad_perm:[2,3,0,1] row_mask:0xf bank_mask:0xf
    s_nop 1
    v_add_f32_dpp v26, v26, v26 row_half_mirror row_mask:0xf bank_mask:0xf
    s_nop 1
    v_add_f32_dpp v26, v26, v26 row_mirror row_mask:0xf bank_mask:0xf
    v_mov_b32 v27, v26
    s_nop 1
    v_permlane16_swap_b32 v26, v27
    v_add_f32 v26, v26, v27
    v_mov_b32 v27, v26
    s_nop 1
    v_permlane32_swap_b32 v26, v27
    v_add_f32 v26, v26, v27
    v_mul_f32 v26, 0x3ae38e39, v26
    v_cvt_pk_bf16_f32 v26, v26, v26
    v_lshlrev_b32 v26, 16, v26
    v_add_f32 v26, 0x3727c5ac, v26
    v_cvt_pk_bf16_f32 v26, v26, v26
    v_lshlrev_b32 v26, 16, v26
    v_sqrt_f32 v29, v26
    v_cvt_pk_bf16_f32 v28, v28, v28
    v_lshlrev_b32 v28, 16, v28
    v_rcp_f32 v30, v29
    v_fma_f32 v31, -v29, v29, v26
    v_mul_f32 v30, 0.5, v30
    v_fmac_f32 v29, v31, v30
    v_cvt_pk_bf16_f32 v29, v29, v29
    v_lshlrev_b32 v29, 16, v29
    v_rcp_f32 v30, v29
    v_sub_f32 v16, v16, v28
    v_cvt_pk_bf16_f32 v16, v16, v16
    v_lshlrev_b32 v16, 16, v16
    v_sub_f32 v17, v17, v28
    v_cvt_pk_bf16_f32 v17, v17, v17
    v_lshlrev_b32 v17, 16, v17
    v_sub_f32 v18, v18, v28
    v_cvt_pk_bf16_f32 v18, v18, v18
    v_lshlrev_b32 v18, 16, v18
    v_sub_f32 v19, v19, v28
    v_cvt_pk_bf16_f32 v19, v19, v19
    v_lshlrev_b32 v19, 16, v19
    v_sub_f32 v20, v20, v28
    v_cvt_pk_bf16_f32 v20, v20, v20
    v_lshlrev_b32 v20, 16, v20
    v_sub_f32 v21, v21, v28
    v_cvt_pk_bf16_f32 v21, v21, v21
    v_lshlrev_b32 v21, 16, v21
    v_sub_f32 v22, v22, v28
    v_cvt_pk_bf16_f32 v22, v22, v22
    v_lshlrev_b32 v22, 16, v22
    v_sub_f32 v23, v23, v28
    v_cvt_pk_bf16_f32 v23, v23, v23
    v_lshlrev_b32 v23, 16, v23
    v_sub_f32 v24, v24, v28
    v_cvt_pk_bf16_f32 v24, v24, v24
    v_lshlrev_b32 v24, 16, v24
    v_mul_f32 v27, v16, v30
    v_fma_f32 v31, -v27, v29, v16
    v_fma_f32 v16, v31, v30, v27
    v_mul_f32 v27, v17, v30
    v_fma_f32 v31, -v27, v29, v17
    v_fma_f32 v17, v31, v30, v27
    v_mul_f32 v27, v18, v30
    v_fma_f32 v31, -v27, v29, v18
    v_fma_f32 v18, v31, v30, v27
    v_mul_f32 v27, v19, v30
    v_fma_f32 v31, -v27, v29, v19
    v_fma_f32 v19, v31, v30, v27
    v_mul_f32 v27, v20, v30
    v_fma_f32 v31, -v27, v29, v20
    v_fma_f32 v20, v31, v30, v27
    v_mul_f32 v27, v21, v30
    v_fma_f32 v31, -v27, v29, v21
    v_fma_f32 v21, v31, v30, v27
    v_mul_f32 v27, v22, v30
    v_fma_f32 v31, -v27, v29, v22
    v_fma_f32 v22, v31, v30, v27
    v_mul_f32 v27, v23, v30
    v_fma_f32 v31, -v27, v29, v23
    v_fma_f32 v23, v31, v30, v27
    v_mul_f32 v27, v24, v30
    v_fma_f32 v31, -v27, v29, v24
    v_fma_f32 v24, v31, v30, v27
    v_cvt_pk_bf16_f32 v16, v16, v16
    ds_write_b16 v4, v16 offset:1024
    v_cvt_pk_bf16_f32 v17, v17, v17
    ds_write_b16 v4, v17 offset:1152
    v_cvt_pk_bf16_f32 v18, v18, v18
    ds_write_b16 v4, v18 offset:1280
    v_cvt_pk_bf16_f32 v19, v19, v19
    ds_write_b16 v4, v19 offset:1408
    v_cvt_pk_bf16_f32 v20, v20, v20
    ds_write_b16 v4, v20 offset:1536
    v_cvt_pk_bf16_f32 v21, v21, v21
    ds_write_b16 v4, v21 offset:1664
    v_cvt_pk_bf16_f32 v22, v22, v22
    ds_write_b16 v4, v22 offset:1792
    v_cvt_pk_bf16_f32 v23, v23, v23
    ds_write_b16 v4, v23 offset:1920
    v_cvt_pk_bf16_f32 v24, v24, v24
    ds_write_b16 v4, v24 offset:2048
    s_branch L_qp_b1
L_qp_hi:
    s_lshl_b32 s57, s84, 7
    s_add_u32 s44, s10, s57
    s_addc_u32 s45, s11, 0
    s_mov_b32 s46, 0x47e080
    s_mov_b32 s47, 0x00020000
    s_sub_u32 s59, s52, 8
    s_mul_i32 s59, s59, 72
    v_lshrrev_b32 v4, 3, v1
    v_add_u32 v4, s59, v4
    v_lshlrev_b32 v4, 13, v4
    v_and_b32 v5, 7, v1
    v_lshl_add_u32 v4, v5, 4, v4
    s_lshl_b32 s57, s59, 7
    s_add_u32 s57, s57, 29184
    s_mov_b32 s58, 0
    s_mov_b32 m0, s57
    s_nop 0
    buffer_load_dwordx4 v4, s[44:47], s58 offen nt lds
    s_add_u32 s57, s57, 1024
    s_add_u32 s58, s58, 65536
    s_mov_b32 m0, s57
    s_nop 0
    buffer_load_dwordx4 v4, s[44:47], s58 offen nt lds
    s_add_u32 s57, s57, 1024
    s_add_u32 s58, s58, 65536
    s_mov_b32 m0, s57
    s_nop 0
    buffer_load_dwordx4 v4, s[44:47], s58 offen nt lds
    s_add_u32 s57, s57, 1024
    s_add_u32 s58, s58, 65536
    s_mov_b32 m0, s57
    s_nop 0
    buffer_load_dwordx4 v4, s[44:47], s58 offen nt lds
    s_add_u32 s57, s57, 1024
    s_add_u32 s58, s58, 65536
    s_mov_b32 m0, s57
    s_nop 0
    buffer_load_dwordx4 v4, s[44:47], s58 offen nt lds
    s_add_u32 s57, s57, 1024
    s_add_u32 s58, s58, 65536
    s_mov_b32 m0, s57
    s_nop 0
    buffer_load_dwordx4 v4, s[44:47], s58 offen nt lds
    s_add_u32 s57, s57, 1024
    s_add_u32 s58, s58, 65536
    s_mov_b32 m0, s57
    s_nop 0
    buffer_load_dwordx4 v4, s[44:47], s58 offen nt lds
    s_add_u32 s57, s57, 1024
    s_add_u32 s58, s58, 65536
    s_mov_b32 m0, s57
    s_nop 0
    buffer_load_dwordx4 v4, s[44:47], s58 offen nt lds
    s_add_u32 s57, s57, 1024
    s_add_u32 s58, s58, 65536
    s_mov_b32 m0, s57
    s_nop 0
    buffer_load_dwordx4 v4, s[44:47], s58 offen nt lds
    s_cmp_lt_u32 s52, 14
    s_cbranch_scc1 L_hk1_done
    s_cmp_eq_u32 s52, 14
    s_cbranch_scc1 L_hk1_clr
    v_mov_b32 v16, 32
    ds_write_b32 v120, v16 offset:0
    s_branch L_hk1_done
L_hk1_clr:
    v_mov_b32 v16, -1
    v_mov_b32 v17, -1
    v_mov_b32 v18, -1
    v_mov_b32 v19, -1
    s_lshl_b32 s58, s56, 10
    s_add_u32 s58, s58, 0xd0000
    s_cmp_lt_u32 s56, 72
    s_cselect_b32 s58, s58, 0x200000
    buffer_store_dwordx4 v[16:19], v3, s[36:39], s58 offen sc1
    s_nop 1
L_hk1_done:
    v_and_b32 v4, 1, v1
    v_lshlrev_b32 v4, 4, v4
    v_mov_b32 v6, 0xffff
    v_lshlrev_b32 v6, v4, v6
    v_bfe_u32 v4, v1, 1, 2
    v_cmp_eq_u32 vcc, 0, v4
    s_nop 1
    v_cndmask_b32 v8, 0, v6, vcc
    v_cmp_eq_u32 vcc, 1, v4
    s_nop 1
    v_cndmask_b32 v9, 0, v6, vcc
    v_cmp_eq_u32 vcc, 2, v4
    s_nop 1
    v_cndmask_b32 v10, 0, v6, vcc
    v_cmp_eq_u32 vcc, 3, v4
    s_nop 1
    v_cndmask_b32 v11, 0, v6, vcc
    s_waitcnt vmcnt(0)
    s_nop 0
L_qp_b1:
    s_waitcnt lgkmcnt(0)
    s_add_u32 s67, s67, 1
    s_mul_i32 s3, s67, 0x9E3779B1
    s_barrier
    s_cmp_ge_u32 s52, 12
    s_cbranch_scc1 L_qp_b2
    v_and_b32 v4, 7, v1
    v_mul_u32_u24 v4, 1216, v4
    v_lshrrev_b32 v5, 4, v1
    v_lshl_add_u32 v4, v5, 4, v4
    v_bfe_u32 v6, v1, 2, 2
    v_lshl_add_u32 v6, v5, 3, v6
    v_lshlrev_b32 v6, 7, v6
    v_and_b32 v7, 3, v1
    v_lshl_add_u32 v6, v7, 3, v6
    s_lshr_b32 s57, s52, 2
    s_mul_i32 s58, s57, 384
    v_add_u32 v4, s58, v4
    s_mul_i32 s57, s57, 24576
    s_and_b32 s58, s52, 3
    s_lshl_b32 s58, s58, 5
    s_add_u32 s57, s57, s58
    s_add_u32 s57, s57, 29184
    v_add_u32 v6, s57, v6
    ds_read_b128 v[56:59], v4 offset:1024
    ds_read_b64_tr_b16 v[80:81], v6 offset:0
    ds_read_b64_tr_b16 v[82:83], v6 offset:512
    ds_read_b128 v[60:63], v4 offset:1088
    ds_read_b64_tr_b16 v[84:85], v6 offset:4096
    ds_read_b64_tr_b16 v[86:87], v6 offset:4608
    ds_read_b128 v[64:67], v4 offset:1152
    ds_read_b64_tr_b16 v[88:89], v6 offset:8192
    ds_read_b64_tr_b16 v[90:91], v6 offset:8704
    ds_read_b128 v[68:71], v4 offset:1216
    ds_read_b64_tr_b16 v[92:93], v6 offset:12288
    ds_read_b64_tr_b16 v[94:95], v6 offset:12800
    ds_read_b128 v[72:75], v4 offset:1280
    ds_read_b64_tr_b16 v[96:97], v6 offset:16384
    ds_read_b64_tr_b16 v[98:99], v6 offset:16896
    ds_read_b128 v[76:79], v4 offset:1344
    ds_read_b64_tr_b16 v[100:101], v6 offset:20480
    ds_read_b64_tr_b16 v[102:103], v6 offset:20992
    v_lshlrev_b32 v4, 8, v5
    v_and_b32 v6, 15, v1
    v_lshl_add_u32 v4, v6, 2, v4
    s_lshl_b32 s57, s52, 9
    v_add_u32 v4, s57, v4
    s_waitcnt lgkmcnt(15)
    v_mfma_f32_16x16x32_bf16 v[104:107], v[56:59], v[80:83], 0
    s_waitcnt lgkmcnt(12)
    v_mfma_f32_16x16x32_bf16 v[104:107], v[60:63], v[84:87], v[104:107]
    s_waitcnt lgkmcnt(9)
    v_mfma_f32_16x16x32_bf16 v[104:107], v[64:67], v[88:91], v[104:107]
    s_waitcnt lgkmcnt(6)
    v_mfma_f32_16x16x32_bf16 v[104:107], v[68:71], v[92:95], v[104:107]
    s_waitcnt lgkmcnt(3)
    v_mfma_f32_16x16x32_bf16 v[104:107], v[72:75], v[96:99], v[104:107]
    s_waitcnt lgkmcnt(0)
    v_mfma_f32_16x16x32_bf16 v[104:107], v[76:79], v[100:103], v[104:107]
    s_mov_b32 exec_lo, 0xffffffff
    s_mov_b32 exec_hi, 0x0
    s_nop 5
    ds_write_b32 v4, v104 offset:10752
    ds_write_b32 v4, v105 offset:10816
    ds_write_b32 v4, v106 offset:10880
    ds_write_b32 v4, v107 offset:10944
    s_mov_b64 exec, -1
    s_waitcnt lgkmcnt(0)
L_qp_b2:
    s_barrier
    s_cmp_ge_u32 s52, 4
    s_cbranch_scc1 L_qp_ring
    v_lshlrev_b32 v4, 3, v1
    s_lshl_b32 s57, s52, 9
    v_add_u32 v4, s57, v4
    ds_read_b64 v[16:17], v4 offset:10752
    ds_read_b64 v[18:19], v4 offset:12800
    ds_read_b64 v[20:21], v4 offset:14848
    v_lshrrev_b32 v5, 3, v1
    v_lshlrev_b32 v5, 14, v5
    v_and_b32 v6, 7, v1
    v_lshl_add_u32 v5, v6, 3, v5
    s_lshl_b32 s57, s84, 8
    s_lshl_b32 s58, s52, 6
    s_add_u32 s57, s57, s58
    s_waitcnt lgkmcnt(0)
    v_add_f32 v16, v16, v18
    v_add_f32 v17, v17, v19
    v_add_f32 v16, v16, v20
    v_add_f32 v17, v17, v21
    v_cvt_pk_bf16_f32 v16, v16, v17
    v_mov_b32 v17, s3
    buffer_store_dwordx2 v[16:17], v5, s[36:39], s57 offen sc1
    s_nop 0
L_qp_ring:
    s_barrier
    s_lshl_b32 s64, s61, 12
    s_waitcnt vmcnt(3)
    buffer_load_dwordx4 v[56:59], v2, s[28:31], s64 offen offset:0 nt
    s_waitcnt vmcnt(3)
    buffer_load_dwordx4 v[60:63], v2, s[28:31], s64 offen offset:1024 nt
    s_waitcnt vmcnt(3)
    buffer_load_dwordx4 v[64:67], v2, s[28:31], s64 offen offset:2048 nt
    s_waitcnt vmcnt(3)
    buffer_load_dwordx4 v[68:71], v2, s[28:31], s64 offen offset:3072 nt
    s_waitcnt vmcnt(3)
    buffer_load_dwordx4 v[72:75], v3, s[32:35], s64 offen offset:0 nt
    s_waitcnt vmcnt(3)
    buffer_load_dwordx4 v[76:79], v3, s[32:35], s64 offen offset:1024 nt
    s_waitcnt vmcnt(3)
    buffer_load_dwordx4 v[80:83], v3, s[32:35], s64 offen offset:2048 nt
    s_waitcnt vmcnt(3)
    buffer_load_dwordx4 v[84:87], v3, s[32:35], s64 offen offset:3072 nt
    s_lshl_b32 s64, s62, 12
    s_waitcnt vmcnt(3)
    buffer_load_dwordx4 v[88:91], v2, s[28:31], s64 offen offset:0 nt
    s_waitcnt vmcnt(3)
    buffer_load_dwordx4 v[92:95], v2, s[28:31], s64 offen offset:1024 nt
    s_waitcnt vmcnt(3)
    buffer_load_dwordx4 v[96:99], v2, s[28:31], s64 offen offset:2048 nt
    s_waitcnt vmcnt(3)
    buffer_load_dwordx4 v[100:103], v2, s[28:31], s64 offen offset:3072 nt
    s_waitcnt vmcnt(3)
    buffer_load_dwordx4 v[104:107], v3, s[32:35], s64 offen offset:0 nt
    s_waitcnt vmcnt(3)
    buffer_load_dwordx4 v[108:111], v3, s[32:35], s64 offen offset:1024 nt
    s_waitcnt vmcnt(3)
    buffer_load_dwordx4 v[112:115], v3, s[32:35], s64 offen offset:2048 nt
    s_waitcnt vmcnt(3)
    buffer_load_dwordx4 v[116:119], v3, s[32:35], s64 offen offset:3072 nt
L_gather:
    s_lshl_b32 s57, s53, 4
    s_add_u32 s57, s57, s52
    s_lshl_b32 s57, s57, 6
    s_lshl_b32 s59, s54, 14
    s_add_u32 s57, s57, s59
    s_add_u32 s40, s26, s57
    s_addc_u32 s41, s27, 0
    s_mov_b32 s1, 0
L_q_poll:
    s_load_dwordx16 s[68:83], s[40:41], 0 glc
    s_waitcnt lgkmcnt(0)
    s_add_u32 s1, s1, 1
    s_xor_b32 s57, s69, s3
    s_xor_b32 s58, s71, s3
    s_or_b32 s57, s57, s58
    s_xor_b32 s58, s73, s3
    s_or_b32 s57, s57, s58
    s_xor_b32 s58, s75, s3
    s_or_b32 s57, s57, s58
    s_xor_b32 s58, s77, s3
    s_or_b32 s57, s57, s58
    s_xor_b32 s58, s79, s3
    s_or_b32 s57, s57, s58
    s_xor_b32 s58, s81, s3
    s_or_b32 s57, s57, s58
    s_xor_b32 s58, s83, s3
    s_or_b32 s57, s57, s58
    s_cmp_eq_u32 s57, 0
    s_cbranch_scc1 L_q_seen
    s_sleep 12
    s_cmp_lt_u32 s1, 200000
    s_cbranch_scc1 L_q_poll
L_q_seen:
    s_lshl_b32 s57, s52, 5
    v_mov_b32 v4, s57
    v_mov_b32 v16, s68
    v_mov_b32 v17, s70
    v_mov_b32 v18, s72
    v_mov_b32 v19, s74
    v_mov_b32 v20, s76
    v_mov_b32 v21, s78
    v_mov_b32 v22, s80
    v_mov_b32 v23, s82
    s_mov_b64 exec, 1
    ds_write_b128 v4, v[16:19] offset:512
    ds_write_b128 v4, v[20:23] offset:528
    s_mov_b64 exec, -1
    v_lshrrev_b32 v4, 4, v1
    v_and_b32 v5, 3, v1
    v_lshl_add_u32 v4, v4, 2, v5
    v_bfe_u32 v5, v1, 3, 1
    v_lshl_add_u32 v4, v5, 4, v4
    v_lshlrev_b32 v4, 4, v4
    s_waitcnt lgkmcnt(0)
    s_barrier
    s_cmp_lg_u32 s2, 190
    s_cbranch_scc1 L_noz
    s_cmp_lg_u32 s52, 12
    s_cbranch_scc1 L_noz
    v_mov_b32 v20, s3
    s_mov_b32 s58, 0xa2000
    s_mov_b64 exec, 1
    buffer_store_dword v20, v120, s[36:39], s58 offen sc1
    s_mov_b64 exec, -1
L_noz:
    ds_read_b128 v[12:15], v4 offset:512
    s_mov_b64 exec, 1
    ds_add_rtn_u32 v47, v120, v121 offset:0
    s_mov_b64 exec, -1
    v_mov_b32 v44, 0xff800000
    v_mov_b32 v45, 0
    v_mov_b32 v16, 0
    v_mov_b32 v17, 0
    v_mov_b32 v18, 0
    v_mov_b32 v19, 0
    s_nop 1
L_loop:
    s_waitcnt lgkmcnt(0)
    v_readfirstlane_b32 s63, v47
    s_mov_b64 exec, 1
    ds_add_rtn_u32 v47, v120, v121 offset:0
    s_mov_b64 exec, -1
    s_lshl_b32 s64, s63, 12
    s_waitcnt vmcnt(11)
    v_mfma_f32_16x16x32_bf16 v[28:31], v[56:59], v[12:15], 0
    buffer_load_dwordx4 v[56:59], v2, s[28:31], s64 offen offset:0 nt
    s_waitcnt vmcnt(11)
    v_mfma_f32_16x16x32_bf16 v[32:35], v[60:63], v[12:15], 0
    buffer_load_dwordx4 v[60:63], v2, s[28:31], s64 offen offset:1024 nt
    s_waitcnt vmcnt(11)
    v_mfma_f32_16x16x32_bf16 v[36:39], v[64:67], v[12:15], 0
    buffer_load_dwordx4 v[64:67], v2, s[28:31], s64 offen offset:2048 nt
    s_waitcnt vmcnt(11)
    v_mfma_f32_16x16x32_bf16 v[40:43], v[68:71], v[12:15], 0
    buffer_load_dwordx4 v[68:71], v2, s[28:31], s64 offen offset:3072 nt
    v_mov_b32_dpp v48, v28 quad_perm:[0,0,0,0] row_mask:0xf bank_mask:0xf
    v_add_f32_dpp v48, v29, v48 quad_perm:[1,1,1,1] row_mask:0xf bank_mask:0xf
    v_add_f32_dpp v48, v30, v48 quad_perm:[2,2,2,2] row_mask:0xf bank_mask:0xf
    v_add_f32_dpp v48, v31, v48 quad_perm:[3,3,3,3] row_mask:0xf bank_mask:0xf
    v_mov_b32_dpp v49, v32 quad_perm:[0,0,0,0] row_mask:0xf bank_mask:0xf
    v_add_f32_dpp v49, v33, v49 quad_perm:[1,1,1,1] row_mask:0xf bank_mask:0xf
    v_add_f32_dpp v49, v34, v49 quad_perm:[2,2,2,2] row_mask:0xf bank_mask:0xf
    v_add_f32_dpp v49, v35, v49 quad_perm:[3,3,3,3] row_mask:0xf bank_mask:0xf
    v_mov_b32_dpp v50, v36 quad_perm:[0,0,0,0] row_mask:0xf bank_mask:0xf
    v_add_f32_dpp v50, v37, v50 quad_perm:[1,1,1,1] row_mask:0xf bank_mask:0xf
    v_add_f32_dpp v50, v38, v50 quad_perm:[2,2,2,2] row_mask:0xf bank_mask:0xf
    v_add_f32_dpp v50, v39, v50 quad_perm:[3,3,3,3] row_mask:0xf bank_mask:0xf
    v_mov_b32_dpp v51, v40 quad_perm:[0,0,0,0] row_mask:0xf bank_mask:0xf
    v_add_f32_dpp v51, v41, v51 quad_perm:[1,1,1,1] row_mask:0xf bank_mask:0xf
    v_add_f32_dpp v51, v42, v51 quad_perm:[2,2,2,2] row_mask:0xf bank_mask:0xf
    v_add_f32_dpp v51, v43, v51 quad_perm:[3,3,3,3] row_mask:0xf bank_mask:0xf
    v_cvt_pk_bf16_f32 v52, v48, v49
    v_lshlrev_b32 v48, 16, v52
    v_and_b32 v49, s65, v52
    v_mul_f32 v48, 0x3db504f3, v48
    v_mul_f32 v49, 0x3db504f3, v49
    v_cvt_pk_bf16_f32 v52, v48, v49
    v_lshlrev_b32 v48, 16, v52
    v_and_b32 v49, s65, v52
    v_cvt_pk_bf16_f32 v53, v50, v51
    v_lshlrev_b32 v50, 16, v53
    v_and_b32 v51, s65, v53
    v_mul_f32 v50, 0x3db504f3, v50
    v_mul_f32 v51, 0x3db504f3, v51
    v_cvt_pk_bf16_f32 v53, v50, v51
    v_lshlrev_b32 v50, 16, v53
    v_and_b32 v51, s65, v53
    v_max3_f32 v52, v48, v49, v50
    v_max3_f32 v52, v52, v51, v44
    v_mov_b32 v53, v52
    s_nop 1
    v_permlane16_swap_b32 v52, v53
    v_max_f32 v52, v52, v53
    v_mov_b32 v53, v52
    s_nop 1
    v_permlane32_swap_b32 v52, v53
    v_max_f32 v52, v52, v53
    v_sub_f32 v53, v44, v52
    v_mul_f32 v53, 0x3fb8aa3b, v53
    v_exp_f32 v53, v53
    v_mov_b32 v44, v52
    v_mul_f32 v46, 0xbfb8aa3b, v52
    v_mul_f32 v45, v45, v53
    v_mul_f32 v16, v16, v53
    v_mul_f32 v17, v17, v53
    v_mul_f32 v18, v18, v53
    v_mul_f32 v19, v19, v53
    v_fma_f32 v48, v48, s66, v46
    v_exp_f32 v48, v48
    s_nop 0
    v_add_f32 v45, v45, v48
    v_cvt_pk_bf16_f32 v48, v48, v48
    v_and_b32 v20, v48, v8
    v_and_b32 v21, v48, v9
    v_and_b32 v22, v48, v10
    v_and_b32 v23, v48, v11
    s_waitcnt vmcnt(11)
    s_nop 0
    v_mfma_f32_16x16x32_bf16 v[16:19], v[72:75], v[20:23], v[16:19]
    buffer_load_dwordx4 v[72:75], v3, s[32:35], s64 offen offset:0 nt
    v_fma_f32 v49, v49, s66, v46
    v_exp_f32 v49, v49
    s_nop 0
    v_add_f32 v45, v45, v49
    v_cvt_pk_bf16_f32 v49, v49, v49
    v_and_b32 v24, v49, v8
    v_and_b32 v25, v49, v9
    v_and_b32 v26, v49, v10
    v_and_b32 v27, v49, v11
    s_waitcnt vmcnt(11)
    s_nop 0
    v_mfma_f32_16x16x32_bf16 v[16:19], v[76:79], v[24:27], v[16:19]
    buffer_load_dwordx4 v[76:79], v3, s[32:35], s64 offen offset:1024 nt
    v_fma_f32 v50, v50, s66, v46
    v_exp_f32 v50, v50
    s_nop 0
    v_add_f32 v45, v45, v50
    v_cvt_pk_bf16_f32 v50, v50, v50
    v_and_b32 v20, v50, v8
    v_and_b32 v21, v50, v9
    v_and_b32 v22, v50, v10
    v_and_b32 v23, v50, v11
    s_waitcnt vmcnt(11)
    s_nop 0
    v_mfma_f32_16x16x32_bf16 v[16:19], v[80:83], v[20:23], v[16:19]
    buffer_load_dwordx4 v[80:83], v3, s[32:35], s64 offen offset:2048 nt
    v_fma_f32 v51, v51, s66, v46
    v_exp_f32 v51, v51
    s_nop 0
    v_add_f32 v45, v45, v51
    v_cvt_pk_bf16_f32 v51, v51, v51
    v_and_b32 v24, v51, v8
    v_and_b32 v25, v51, v9
    v_and_b32 v26, v51, v10
    v_and_b32 v27, v51, v11
    s_waitcnt vmcnt(11)
    s_nop 0
    v_mfma_f32_16x16x32_bf16 v[16:19], v[84:87], v[24:27], v[16:19]
    buffer_load_dwordx4 v[84:87], v3, s[32:35], s64 offen offset:3072 nt
    s_mov_b32 s61, s63
    s_cmp_ge_u32 s62, s48
    s_cbranch_scc1 L_loop_exit
    s_waitcnt lgkmcnt(0)
    v_readfirstlane_b32 s63, v47
    s_mov_b64 exec, 1
    ds_add_rtn_u32 v47, v120, v121 offset:0
    s_mov_b64 exec, -1
    s_lshl_b32 s64, s63, 12
    s_waitcnt vmcnt(11)
    v_mfma_f32_16x16x32_bf16 v[28:31], v[88:91], v[12:15], 0
    buffer_load_dwordx4 v[88:91], v2, s[28:31], s64 offen offset:0 nt
    s_waitcnt vmcnt(11)
    v_mfma_f32_16x16x32_bf16 v[32:35], v[92:95], v[12:15], 0
    buffer_load_dwordx4 v[92:95], v2, s[28:31], s64 offen offset:1024 nt
    s_waitcnt vmcnt(11)
    v_mfma_f32_16x16x32_bf16 v[36:39], v[96:99], v[12:15], 0
    buffer_load_dwordx4 v[96:99], v2, s[28:31], s64 offen offset:2048 nt
    s_waitcnt vmcnt(11)
    v_mfma_f32_16x16x32_bf16 v[40:43], v[100:103], v[12:15], 0
    buffer_load_dwordx4 v[100:103], v2, s[28:31], s64 offen offset:3072 nt
    v_mov_b32_dpp v48, v28 quad_perm:[0,0,0,0] row_mask:0xf bank_mask:0xf
    v_add_f32_dpp v48, v29, v48 quad_perm:[1,1,1,1] row_mask:0xf bank_mask:0xf
    v_add_f32_dpp v48, v30, v48 quad_perm:[2,2,2,2] row_mask:0xf bank_mask:0xf
    v_add_f32_dpp v48, v31, v48 quad_perm:[3,3,3,3] row_mask:0xf bank_mask:0xf
    v_mov_b32_dpp v49, v32 quad_perm:[0,0,0,0] row_mask:0xf bank_mask:0xf
    v_add_f32_dpp v49, v33, v49 quad_perm:[1,1,1,1] row_mask:0xf bank_mask:0xf
    v_add_f32_dpp v49, v34, v49 quad_perm:[2,2,2,2] row_mask:0xf bank_mask:0xf
    v_add_f32_dpp v49, v35, v49 quad_perm:[3,3,3,3] row_mask:0xf bank_mask:0xf
    v_mov_b32_dpp v50, v36 quad_perm:[0,0,0,0] row_mask:0xf bank_mask:0xf
    v_add_f32_dpp v50, v37, v50 quad_perm:[1,1,1,1] row_mask:0xf bank_mask:0xf
    v_add_f32_dpp v50, v38, v50 quad_perm:[2,2,2,2] row_mask:0xf bank_mask:0xf
    v_add_f32_dpp v50, v39, v50 quad_perm:[3,3,3,3] row_mask:0xf bank_mask:0xf
    v_mov_b32_dpp v51, v40 quad_perm:[0,0,0,0] row_mask:0xf bank_mask:0xf
    v_add_f32_dpp v51, v41, v51 quad_perm:[1,1,1,1] row_mask:0xf bank_mask:0xf
    v_add_f32_dpp v51, v42, v51 quad_perm:[2,2,2,2] row_mask:0xf bank_mask:0xf
    v_add_f32_dpp v51, v43, v51 quad_perm:[3,3,3,3] row_mask:0xf bank_mask:0xf
    v_cvt_pk_bf16_f32 v52, v48, v49
    v_lshlrev_b32 v48, 16, v52
    v_and_b32 v49, s65, v52
    v_mul_f32 v48, 0x3db504f3, v48
    v_mul_f32 v49, 0x3db504f3, v49
    v_cvt_pk_bf16_f32 v52, v48, v49
    v_lshlrev_b32 v48, 16, v52
    v_and_b32 v49, s65, v52
    v_cvt_pk_bf16_f32 v53, v50, v51
    v_lshlrev_b32 v50, 16, v53
    v_and_b32 v51, s65, v53
    v_mul_f32 v50, 0x3db504f3, v50
    v_mul_f32 v51, 0x3db504f3, v51
    v_cvt_pk_bf16_f32 v53, v50, v51
    v_lshlrev_b32 v50, 16, v53
    v_and_b32 v51, s65, v53
    v_max3_f32 v52, v48, v49, v50
    v_max3_f32 v52, v52, v51, v44
    v_mov_b32 v53, v52
    s_nop 1
    v_permlane16_swap_b32 v52, v53
    v_max_f32 v52, v52, v53
    v_mov_b32 v53, v52
    s_nop 1
    v_permlane32_swap_b32 v52, v53
    v_max_f32 v52, v52, v53
    v_sub_f32 v53, v44, v52
    v_mul_f32 v53, 0x3fb8aa3b, v53
    v_exp_f32 v53, v53
    v_mov_b32 v44, v52
    v_mul_f32 v46, 0xbfb8aa3b, v52
    v_mul_f32 v45, v45, v53
    v_mul_f32 v16, v16, v53
    v_mul_f32 v17, v17, v53
    v_mul_f32 v18, v18, v53
    v_mul_f32 v19, v19, v53
    v_fma_f32 v48, v48, s66, v46
    v_exp_f32 v48, v48
    s_nop 0
    v_add_f32 v45, v45, v48
    v_cvt_pk_bf16_f32 v48, v48, v48
    v_and_b32 v20, v48, v8
    v_and_b32 v21, v48, v9
    v_and_b32 v22, v48, v10
    v_and_b32 v23, v48, v11
    s_waitcnt vmcnt(11)
    s_nop 0
    v_mfma_f32_16x16x32_bf16 v[16:19], v[104:107], v[20:23], v[16:19]
    buffer_load_dwordx4 v[104:107], v3, s[32:35], s64 offen offset:0 nt
    v_fma_f32 v49, v49, s66, v46
    v_exp_f32 v49, v49
    s_nop 0
    v_add_f32 v45, v45, v49
    v_cvt_pk_bf16_f32 v49, v49, v49
    v_and_b32 v24, v49, v8
    v_and_b32 v25, v49, v9
    v_and_b32 v26, v49, v10
    v_and_b32 v27, v49, v11
    s_waitcnt vmcnt(11)
    s_nop 0
    v_mfma_f32_16x16x32_bf16 v[16:19], v[108:111], v[24:27], v[16:19]
    buffer_load_dwordx4 v[108:111], v3, s[32:35], s64 offen offset:1024 nt
    v_fma_f32 v50, v50, s66, v46
    v_exp_f32 v50, v50
    s_nop 0
    v_add_f32 v45, v45, v50
    v_cvt_pk_bf16_f32 v50, v50, v50
    v_and_b32 v20, v50, v8
    v_and_b32 v21, v50, v9
    v_and_b32 v22, v50, v10
    v_and_b32 v23, v50, v11
    s_waitcnt vmcnt(11)
    s_nop 0
    v_mfma_f32_16x16x32_bf16 v[16:19], v[112:115], v[20:23], v[16:19]
    buffer_load_dwordx4 v[112:115], v3, s[32:35], s64 offen offset:2048 nt
    v_fma_f32 v51, v51, s66, v46
    v_exp_f32 v51, v51
    s_nop 0
    v_add_f32 v45, v45, v51
    v_cvt_pk_bf16_f32 v51, v51, v51
    v_and_b32 v24, v51, v8
    v_and_b32 v25, v51, v9
    v_and_b32 v26, v51, v10
    v_and_b32 v27, v51, v11
    s_waitcnt vmcnt(11)
    s_nop 0
    v_mfma_f32_16x16x32_bf16 v[16:19], v[116:119], v[24:27], v[16:19]
    buffer_load_dwordx4 v[116:119], v3, s[32:35], s64 offen offset:3072 nt
    s_mov_b32 s62, s63
    s_cmp_lt_u32 s61, s48
    s_cbranch_scc1 L_loop
    s_nop 3
L_loop_exit:
    v_mov_b32 v5, v45
    s_nop 1
    v_permlane16_swap_b32 v45, v5
    v_add_f32 v45, v45, v5
    v_mov_b32 v5, v45
    s_nop 1
    v_permlane32_swap_b32 v45, v5
    v_add_f32 v45, v45, v5
    s_lshl_b32 s57, s52, 10
    v_add_u32 v4, s57, v3
    ds_write_b128 v4, v[16:19] offset:10752
    v_bfe_u32 v5, v1, 3, 1
    v_lshlrev_b32 v5, 3, v5
    s_lshl_b32 s57, s52, 4
    v_add_u32 v6, s57, v5
    ds_write_b64 v6, v[44:45] offset:64
    s_waitcnt vmcnt(0) lgkmcnt(0)
    s_barrier
    s_cmp_ge_u32 s52, 4
    s_cbranch_scc1 L_tail
    v_and_b32 v4, 15, v1
    v_lshlrev_b32 v4, 4, v4
    v_lshrrev_b32 v5, 5, v1
    v_lshl_add_u32 v4, v5, 3, v4
    ds_read_b64 v[8:9], v4 offset:64
    v_lshlrev_b32 v6, 2, v0
    ds_read_b32 v16, v6 offset:10752
    ds_read_b32 v17, v6 offset:11776
    ds_read_b32 v18, v6 offset:12800
    ds_read_b32 v19, v6 offset:13824
    ds_read_b32 v20, v6 offset:14848
    ds_read_b32 v21, v6 offset:15872
    ds_read_b32 v22, v6 offset:16896
    ds_read_b32 v23, v6 offset:17920
    ds_read_b32 v24, v6 offset:18944
    ds_read_b32 v25, v6 offset:19968
    ds_read_b32 v26, v6 offset:20992
    ds_read_b32 v27, v6 offset:22016
    ds_read_b32 v28, v6 offset:23040
    ds_read_b32 v29, v6 offset:24064
    ds_read_b32 v30, v6 offset:25088
    ds_read_b32 v31, v6 offset:26112
    v_lshlrev_b32 v6, 3, v0
    s_lshl_b32 s57, s56, 11
    s_add_u32 s57, s57, 0x20000
    v_lshlrev_b32 v5, 4, v5
    s_lshl_b32 s58, s56, 5
    s_add_u32 s58, s58, 0xa0000
    v_mov_b32 v13, s3
    v_mov_b32 v33, s3
    v_mov_b32 v35, s3
    s_waitcnt lgkmcnt(15)
    v_mov_b32 v32, v8
    s_nop 1
    v_max_f32_dpp v32, v32, v32 quad_perm:[1,0,3,2] row_mask:0xf bank_mask:0xf
    s_nop 1
    v_max_f32_dpp v32, v32, v32 quad_perm:[2,3,0,1] row_mask:0xf bank_mask:0xf
    s_nop 1
    v_max_f32_dpp v32, v32, v32 row_half_mirror row_mask:0xf bank_mask:0xf
    s_nop 1
    v_max_f32_dpp v32, v32, v32 row_mirror row_mask:0xf bank_mask:0xf
    v_sub_f32 v8, v8, v32
    v_mul_f32 v8, 0x3fb8aa3b, v8
    v_exp_f32 v8, v8
    s_nop 0
    v_mul_f32 v34, v8, v9
    s_nop 1
    v_add_f32_dpp v34, v34, v34 quad_perm:[1,0,3,2] row_mask:0xf bank_mask:0xf
    s_nop 1
    v_add_f32_dpp v34, v34, v34 quad_perm:[2,3,0,1] row_mask:0xf bank_mask:0xf
    s_nop 1
    v_add_f32_dpp v34, v34, v34 row_half_mirror row_mask:0xf bank_mask:0xf
    s_nop 1
    v_add_f32_dpp v34, v34, v34 row_mirror row_mask:0xf bank_mask:0xf
    v_mul_f32_dpp v12, v8, v16 row_newbcast:0 row_mask:0xf bank_mask:0xf
    s_waitcnt lgkmcnt(14)
    v_fmac_f32_dpp v12, v8, v17 row_newbcast:1 row_mask:0xf bank_mask:0xf
    s_waitcnt lgkmcnt(13)
    v_fmac_f32_dpp v12, v8, v18 row_newbcast:2 row_mask:0xf bank_mask:0xf
    s_waitcnt lgkmcnt(12)
    v_fmac_f32_dpp v12, v8, v19 row_newbcast:3 row_mask:0xf bank_mask:0xf
    s_waitcnt lgkmcnt(11)
    v_fmac_f32_dpp v12, v8, v20 row_newbcast:4 row_mask:0xf bank_mask:0xf
    s_waitcnt lgkmcnt(10)
    v_fmac_f32_dpp v12, v8, v21 row_newbcast:5 row_mask:0xf bank_mask:0xf
    s_waitcnt lgkmcnt(9)
    v_fmac_f32_dpp v12, v8, v22 row_newbcast:6 row_mask:0xf bank_mask:0xf
    s_waitcnt lgkmcnt(8)
    v_fmac_f32_dpp v12, v8, v23 row_newbcast:7 row_mask:0xf bank_mask:0xf
    s_waitcnt lgkmcnt(7)
    v_fmac_f32_dpp v12, v8, v24 row_newbcast:8 row_mask:0xf bank_mask:0xf
    s_waitcnt lgkmcnt(6)
    v_fmac_f32_dpp v12, v8, v25 row_newbcast:9 row_mask:0xf bank_mask:0xf
    s_waitcnt lgkmcnt(5)
    v_fmac_f32_dpp v12, v8, v26 row_newbcast:10 row_mask:0xf bank_mask:0xf
    s_waitcnt lgkmcnt(4)
    v_fmac_f32_dpp v12, v8, v27 row_newbcast:11 row_mask:0xf bank_mask:0xf
    s_waitcnt lgkmcnt(3)
    v_fmac_f32_dpp v12, v8, v28 row_newbcast:12 row_mask:0xf bank_mask:0xf
    s_waitcnt lgkmcnt(2)
    v_fmac_f32_dpp v12, v8, v29 row_newbcast:13 row_mask:0xf bank_mask:0xf
    s_waitcnt lgkmcnt(1)
    v_fmac_f32_dpp v12, v8, v30 row_newbcast:14 row_mask:0xf bank_mask:0xf
    s_waitcnt lgkmcnt(0)
    v_fmac_f32_dpp v12, v8, v31 row_newbcast:15 row_mask:0xf bank_mask:0xf
    buffer_store_dwordx2 v[12:13], v6, s[36:39], s57 offen sc1
    s_cmp_lg_u32 s52, 0
    s_cbranch_scc1 L_tail
    s_mov_b32 exec_lo, 0x1
    s_mov_b32 exec_hi, 0x1
    buffer_store_dwordx4 v[32:35], v5, s[36:39], s58 offen sc1
    s_mov_b64 exec, -1
    s_nop 0
L_tail:
    s_cmp_ge_u32 s2, 216
    s_cbranch_scc1 L_fin
    s_cmp_ge_u32 s2, 72
    s_cbranch_scc1 L_GU
    s_and_b32 s84, s2, 7
    s_lshr_b32 s85, s2, 3
    v_lshrrev_b32 v4, 7, v0
    v_and_b32 v5, 127, v0
    v_lshlrev_b32 v28, 12, v4
    v_lshl_add_u32 v28, v5, 4, v28
    v_bfe_u32 v7, v5, 4, 1
    v_lshlrev_b32 v29, 6, v4
    v_lshl_add_u32 v29, v7, 4, v29
    v_mul_u32_u24 v30, 1088, v4
    v_lshl_add_u32 v30, v7, 8, v30
    v_lshrrev_b32 v6, 5, v5
    v_lshl_add_u32 v30, v6, 6, v30
    v_and_b32 v6, 1, v5
    v_lshl_add_u32 v30, v6, 5, v30
    v_bfe_u32 v6, v5, 1, 3
    v_lshl_add_u32 v30, v6, 1, v30
    s_lshl_b32 s68, s84, 16
    s_add_u32 s68, s68, 0x20000
    s_add_u32 s69, s68, 0x8000
    s_lshl_b32 s70, s84, 10
    s_add_u32 s70, s70, 0xa0000
    s_cmp_lg_u32 s52, 4
    s_cbranch_scc1 L_o_b5
    s_mov_b32 s58, 0xa2000
    s_mov_b32 s1, 0
L_e1:
    buffer_load_dwordx4 v[16:19], v3, s[36:39], s70 offen sc1
    buffer_load_dword v20, v120, s[36:39], s58 offen sc1
    s_add_u32 s1, s1, 1
    s_waitcnt vmcnt(0)
    v_xor_b32 v17, s3, v17
    v_xor_b32 v19, s3, v19
    v_xor_b32 v20, s3, v20
    v_or3_b32 v17, v17, v19, v20
    v_cmp_eq_u32 vcc, 0, v17
    s_bcnt1_i32_b64 s57, vcc
    s_cmp_ge_u32 s57, 56
    s_cbranch_scc1 L_o_b5
    s_sleep 1
    s_cmp_lt_u32 s1, 200000
    s_cbranch_scc1 L_e1
L_o_b5:
    s_barrier
    s_mov_b32 s1, 0
L_o_ld:
    buffer_load_dwordx4 v[32:35], v28, s[36:39], s68 offen sc1
    buffer_load_dwordx4 v[36:39], v28, s[36:39], s68 offen offset:2048 sc1
    buffer_load_dwordx4 v[40:43], v29, s[36:39], s70 offen offset:0 sc1
    buffer_load_dwordx4 v[44:47], v29, s[36:39], s70 offen offset:32 sc1
    buffer_load_dwordx4 v[48:51], v28, s[36:39], s69 offen sc1
    buffer_load_dwordx4 v[52:55], v28, s[36:39], s69 offen offset:2048 sc1
    buffer_load_dwordx4 v[56:59], v29, s[36:39], s70 offen offset:512 sc1
    buffer_load_dwordx4 v[60:63], v29, s[36:39], s70 offen offset:544 sc1
    s_add_u32 s1, s1, 1
    s_waitcnt vmcnt(0)
    v_xor_b32 v33, s3, v33
    v_xor_b32 v35, s3, v35
    v_xor_b32 v37, s3, v37
    v_xor_b32 v39, s3, v39
    v_xor_b32 v41, s3, v41
    v_xor_b32 v43, s3, v43
    v_xor_b32 v45, s3, v45
    v_xor_b32 v47, s3, v47
    v_xor_b32 v49, s3, v49
    v_xor_b32 v51, s3, v51
    v_xor_b32 v53, s3, v53
    v_xor_b32 v55, s3, v55
    v_xor_b32 v57, s3, v57
    v_xor_b32 v59, s3, v59
    v_xor_b32 v61, s3, v61
    v_xor_b32 v63, s3, v63
    v_or_b32 v33, v33, v35
    v_or3_b32 v33, v33, v37, v39
    v_or3_b32 v33, v33, v41, v43
    v_or3_b32 v33, v33, v45, v47
    v_or3_b32 v33, v33, v49, v51
    v_or3_b32 v33, v33, v53, v55
    v_or3_b32 v33, v33, v57, v59
    v_or3_b32 v33, v33, v61, v63
    v_cmp_ne_u32 vcc, 0, v33
    s_cbranch_vccz L_o_ld_ok
    s_sleep 1
    s_cmp_lt_u32 s1, 200000
    s_cbranch_scc1 L_o_ld
    s_nop 0
L_o_ld_ok:
    v_max_f32 v16, v40, v44
    v_sub_f32 v17, v40, v16
    v_sub_f32 v18, v44, v16
    v_mul_f32 v17, 0x3fb8aa3b, v17
    v_mul_f32 v18, 0x3fb8aa3b, v18
    v_exp_f32 v17, v17
    v_exp_f32 v18, v18
    v_mul_f32 v19, v17, v42
    v_fmac_f32 v19, v18, v46
    v_rcp_f32 v19, v19
    v_mul_f32 v20, v17, v32
    v_fmac_f32 v20, v18, v36
    v_mul_f32 v21, v17, v34
    v_fmac_f32 v21, v18, v38
    v_mul_f32 v20, v20, v19
    v_mul_f32 v21, v21, v19
    v_cvt_pk_bf16_f32 v20, v20, v21
    ds_write_b16 v30, v20 offset:1024
    ds_write_b16_d16_hi v30, v20 offset:1040
    v_max_f32 v22, v56, v60
    v_sub_f32 v23, v56, v22
    v_sub_f32 v24, v60, v22
    v_mul_f32 v23, 0x3fb8aa3b, v23
    v_mul_f32 v24, 0x3fb8aa3b, v24
    v_exp_f32 v23, v23
    v_exp_f32 v24, v24
    v_mul_f32 v25, v23, v58
    v_fmac_f32 v25, v24, v62
    v_rcp_f32 v25, v25
    v_mul_f32 v26, v23, v48
    v_fmac_f32 v26, v24, v52
    v_mul_f32 v27, v23, v50
    v_fmac_f32 v27, v24, v54
    v_mul_f32 v26, v26, v25
    v_mul_f32 v27, v27, v25
    v_cvt_pk_bf16_f32 v26, v26, v27
    ds_write_b16 v30, v26 offset:1536
    ds_write_b16_d16_hi v30, v26 offset:1552
    v_and_b32 v4, 7, v1
    v_mul_u32_u24 v4, 1088, v4
    v_lshrrev_b32 v5, 4, v1
    v_lshl_add_u32 v4, v5, 4, v4
    v_bfe_u32 v6, v1, 2, 2
    v_lshl_add_u32 v6, v5, 3, v6
    v_lshlrev_b32 v6, 7, v6
    v_and_b32 v7, 3, v1
    v_lshl_add_u32 v6, v7, 3, v6
    s_lshr_b32 s57, s52, 2
    s_lshl_b32 s58, s57, 8
    v_add_u32 v4, s58, v4
    s_lshl_b32 s57, s57, 14
    s_and_b32 s58, s52, 3
    s_lshl_b32 s58, s58, 5
    s_add_u32 s57, s57, s58
    s_add_u32 s57, s57, 29184
    v_add_u32 v6, s57, v6
    ds_read_b64_tr_b16 v[80:81], v6 offset:0
    ds_read_b64_tr_b16 v[82:83], v6 offset:512
    ds_read_b64_tr_b16 v[84:85], v6 offset:4096
    ds_read_b64_tr_b16 v[86:87], v6 offset:4608
    ds_read_b64_tr_b16 v[88:89], v6 offset:8192
    ds_read_b64_tr_b16 v[90:91], v6 offset:8704
    ds_read_b64_tr_b16 v[92:93], v6 offset:12288
    ds_read_b64_tr_b16 v[94:95], v6 offset:12800
    s_waitcnt lgkmcnt(0)
    s_barrier
    ds_read_b128 v[64:67], v4 offset:1024
    ds_read_b128 v[68:71], v4 offset:1088
    ds_read_b128 v[72:75], v4 offset:1152
    ds_read_b128 v[76:79], v4 offset:1216
    v_lshlrev_b32 v31, 10, v5
    v_and_b32 v6, 15, v1
    v_lshl_add_u32 v31, v6, 2, v31
    s_lshr_b32 s57, s52, 2
    s_lshl_b32 s57, s57, 11
    s_and_b32 s58, s52, 3
    s_lshl_b32 s58, s58, 6
    s_add_u32 s57, s57, s58
    v_add_u32 v31, s57, v31
    s_waitcnt lgkmcnt(3)
    v_mfma_f32_16x16x32_bf16 v[96:99], v[64:67], v[80:83], 0
    s_waitcnt lgkmcnt(2)
    v_mfma_f32_16x16x32_bf16 v[96:99], v[68:71], v[84:87], v[96:99]
    s_waitcnt lgkmcnt(1)
    v_mfma_f32_16x16x32_bf16 v[96:99], v[72:75], v[88:91], v[96:99]
    s_waitcnt lgkmcnt(0)
    v_mfma_f32_16x16x32_bf16 v[96:99], v[76:79], v[92:95], v[96:99]
    s_mov_b32 exec_lo, 0xffffffff
    s_mov_b32 exec_hi, 0x0
    s_nop 5
    ds_write_b32 v31, v96 offset:10752
    ds_write_b32 v31, v97 offset:11008
    ds_write_b32 v31, v98 offset:11264
    ds_write_b32 v31, v99 offset:11520
    s_mov_b64 exec, -1
    s_waitcnt lgkmcnt(0)
    s_barrier
    s_cmp_ge_u32 s52, 8
    s_cbranch_scc1 L_d_dma
    v_lshlrev_b32 v4, 2, v0
    ds_read_b32 v16, v4 offset:10752
    ds_read_b32 v17, v4 offset:12800
    ds_read_b32 v18, v4 offset:14848
    ds_read_b32 v19, v4 offset:16896
    s_mul_i32 s57, s52, 4608
    s_lshl_b32 s58, s85, 9
    s_add_u32 s57, s57, s58
    s_add_u32 s57, s57, 0xb0000
    v_lshlrev_b32 v5, 3, v1
    s_waitcnt lgkmcnt(0)
    v_add_f32 v16, v16, v17
    v_add_f32 v18, v18, v19
    v_add_f32 v16, v16, v18
    v_floor_f32 v17, v16
    v_sub_f32 v16, v16, v17
    v_cvt_i32_f32 v21, v17
    v_mul_f32 v16, 0x4f800000, v16
    v_cvt_u32_f32 v16, v16
    v_and_or_b32 v20, v16, -16, 1
    buffer_atomic_add_x2 v[20:21], v5, s[36:39], s57 offen sc1
    s_mul_i32 s57, s84, 663552
    s_lshl_b32 s58, s85, 7
    s_add_u32 s57, s57, s58
    s_add_u32 s44, s20, s57
    s_addc_u32 s45, s21, 0
    s_mov_b32 s46, 0xa1c00
    s_mov_b32 s47, 0x00020000
    s_mul_i32 s59, s52, 72
    v_lshrrev_b32 v4, 3, v1
    v_add_u32 v4, s59, v4
    v_mul_u32_u24 v4, 1152, v4
    v_and_b32 v5, 7, v1
    v_lshl_add_u32 v4, v5, 4, v4
    s_lshl_b32 s57, s59, 7
    s_add_u32 s57, s57, 29184
    s_mov_b32 s58, 0
    s_mov_b32 m0, s57
    s_nop 0
    buffer_load_dwordx4 v4, s[44:47], s58 offen nt lds
    s_add_u32 s57, s57, 1024
    s_add_u32 s58, s58, 9216
    s_mov_b32 m0, s57
    s_nop 0
    buffer_load_dwordx4 v4, s[44:47], s58 offen nt lds
    s_add_u32 s57, s57, 1024
    s_add_u32 s58, s58, 9216
    s_mov_b32 m0, s57
    s_nop 0
    buffer_load_dwordx4 v4, s[44:47], s58 offen nt lds
    s_add_u32 s57, s57, 1024
    s_add_u32 s58, s58, 9216
    s_mov_b32 m0, s57
    s_nop 0
    buffer_load_dwordx4 v4, s[44:47], s58 offen nt lds
    s_add_u32 s57, s57, 1024
    s_add_u32 s58, s58, 9216
    s_mov_b32 m0, s57
    s_nop 0
    buffer_load_dwordx4 v4, s[44:47], s58 offen nt lds
    s_add_u32 s57, s57, 1024
    s_add_u32 s58, s58, 9216
    s_mov_b32 m0, s57
    s_nop 0
    buffer_load_dwordx4 v4, s[44:47], s58 offen nt lds
    s_add_u32 s57, s57, 1024
    s_add_u32 s58, s58, 9216
    s_mov_b32 m0, s57
    s_nop 0
    buffer_load_dwordx4 v4, s[44:47], s58 offen nt lds
    s_add_u32 s57, s57, 1024
    s_add_u32 s58, s58, 9216
    s_mov_b32 m0, s57
    s_nop 0
    buffer_load_dwordx4 v4, s[44:47], s58 offen nt lds
    s_add_u32 s57, s57, 1024
    s_add_u32 s58, s58, 9216
    s_mov_b32 m0, s57
    s_nop 0
    buffer_load_dwordx4 v4, s[44:47], s58 offen nt lds
L_d_dma:
    s_cmp_lg_u32 s52, 15
    s_cbranch_scc1 L_d_b8
    v_lshlrev_b32 v6, 9, v1
    s_mov_b32 s57, 0xb0000
    s_mov_b32 s58, 0xa2000
    s_mov_b32 s1, 0
    s_mov_b64 exec, 0x1ff
L_dpre:
    buffer_load_dword v41, v6, s[36:39], s57 offen sc1
    buffer_load_dword v42, v120, s[36:39], s58 offen sc1
    s_add_u32 s1, s1, 1
    s_waitcnt vmcnt(0)
    v_and_b32 v41, 15, v41
    v_cmp_eq_u32 vcc, s3, v42
    s_nop 1
    v_cndmask_b32 v41, 0, v41, vcc
    v_cmp_gt_u32 vcc, 8, v41
    s_cbranch_vccz L_dpre_ok
    s_sleep 2
    s_cmp_lt_u32 s1, 200000
    s_cbranch_scc1 L_dpre
    s_nop 0
L_dpre_ok:
    s_mov_b64 exec, -1
L_d_b8:
    s_waitcnt vmcnt(0)
    s_barrier
    s_and_b32 s57, s52, 7
    s_mul_i32 s57, s57, 576
    s_lshl_b32 s58, s85, 6
    s_add_u32 s57, s57, s58
    v_add_u32 v70, s57, v1
    v_lshlrev_b32 v71, 1, v70
    v_lshlrev_b32 v70, 3, v70
    s_mov_b32 s40, s4
    s_mov_b32 s41, s5
    s_mov_b32 s42, 0x2400
    s_mov_b32 s43, 0x00020000
    s_mov_b32 s44, s22
    s_mov_b32 s45, s23
    s_mov_b32 s46, 0x2400
    s_mov_b32 s47, 0x00020000
    s_mov_b32 s68, 0xb0000
    s_mov_b32 s69, 0xb9000
    s_cmp_ge_u32 s52, 9
    s_cbranch_scc1 L_d_b9
    buffer_load_ushort v72, v71, s[40:43], 0 offen
    buffer_load_dwordx2 v[74:75], v70, s[36:39], s68 offen sc1
    v_and_b32 v4, 7, v1
    v_mul_u32_u24 v4, 9216, v4
    v_lshrrev_b32 v5, 4, v1
    v_lshl_add_u32 v4, v5, 4, v4
    s_mul_i32 s57, s84, 1152
    s_lshl_b32 s58, s52, 7
    s_add_u32 s57, s57, s58
    s_add_u32 s57, s57, 0xd0000
    v_bfe_u32 v6, v1, 2, 2
    v_lshl_add_u32 v6, v5, 3, v6
    v_lshlrev_b32 v6, 7, v6
    v_and_b32 v7, 3, v1
    v_lshl_add_u32 v6, v7, 3, v6
    s_lshl_b32 s58, s52, 13
    s_add_u32 s58, s58, 29184
    v_add_u32 v6, s58, v6
    ds_read_b64_tr_b16 v[16:17], v6 offset:0
    ds_read_b64_tr_b16 v[18:19], v6 offset:512
    ds_read_b64_tr_b16 v[20:21], v6 offset:32
    ds_read_b64_tr_b16 v[22:23], v6 offset:544
    ds_read_b64_tr_b16 v[24:25], v6 offset:64
    ds_read_b64_tr_b16 v[26:27], v6 offset:576
    ds_read_b64_tr_b16 v[28:29], v6 offset:96
    ds_read_b64_tr_b16 v[30:31], v6 offset:608
    ds_read_b64_tr_b16 v[32:33], v6 offset:4096
    ds_read_b64_tr_b16 v[34:35], v6 offset:4608
    ds_read_b64_tr_b16 v[36:37], v6 offset:4128
    ds_read_b64_tr_b16 v[38:39], v6 offset:4640
    ds_read_b64_tr_b16 v[40:41], v6 offset:4160
    ds_read_b64_tr_b16 v[42:43], v6 offset:4672
    ds_read_b64_tr_b16 v[44:45], v6 offset:4192
    ds_read_b64_tr_b16 v[46:47], v6 offset:4704
    v_lshlrev_b32 v65, 10, v5
    v_and_b32 v6, 15, v1
    v_lshl_add_u32 v65, v6, 2, v65
    s_lshl_b32 s58, s52, 11
    v_add_u32 v65, s58, v65
    s_mov_b32 s1, 0
    s_nop 0
L_d_poll:
    buffer_load_dwordx4 v[8:11], v4, s[36:39], s57 offen sc1
    buffer_load_dwordx4 v[12:15], v4, s[36:39], s57 offen offset:64 sc1
    s_add_u32 s1, s1, 1
    s_waitcnt vmcnt(0)
    v_max_u32 v64, v8, v9
    v_max3_u32 v64, v64, v10, v11
    v_max3_u32 v64, v64, v12, v13
    v_max3_u32 v64, v64, v14, v15
    v_cmp_eq_u32 vcc, -1, v64
    s_cbranch_vccz L_d_ok
    s_cmp_lt_u32 s1, 200000
    s_cbranch_scc1 L_d_poll
    s_nop 1
L_d_ok:
    s_waitcnt lgkmcnt(0)
    v_mfma_f32_16x16x32_bf16 v[48:51], v[8:11], v[16:19], 0
    v_mfma_f32_16x16x32_bf16 v[52:55], v[8:11], v[20:23], 0
    v_mfma_f32_16x16x32_bf16 v[56:59], v[8:11], v[24:27], 0
    v_mfma_f32_16x16x32_bf16 v[60:63], v[8:11], v[28:31], 0
    v_mfma_f32_16x16x32_bf16 v[48:51], v[12:15], v[32:35], v[48:51]
    v_mfma_f32_16x16x32_bf16 v[52:55], v[12:15], v[36:39], v[52:55]
    v_mfma_f32_16x16x32_bf16 v[56:59], v[12:15], v[40:43], v[56:59]
    v_mfma_f32_16x16x32_bf16 v[60:63], v[12:15], v[44:47], v[60:63]
    s_mov_b32 exec_lo, 0xffffffff
    s_mov_b32 exec_hi, 0x0
    s_nop 2
    ds_write_b32 v65, v48 offset:10752
    ds_write_b32 v65, v49 offset:11008
    ds_write_b32 v65, v50 offset:11264
    ds_write_b32 v65, v51 offset:11520
    ds_write_b32 v65, v52 offset:10816
    ds_write_b32 v65, v53 offset:11072
    ds_write_b32 v65, v54 offset:11328
    ds_write_b32 v65, v55 offset:11584
    ds_write_b32 v65, v56 offset:10880
    ds_write_b32 v65, v57 offset:11136
    ds_write_b32 v65, v58 offset:11392
    ds_write_b32 v65, v59 offset:11648
    ds_write_b32 v65, v60 offset:10944
    ds_write_b32 v65, v61 offset:11200
    ds_write_b32 v65, v62 offset:11456
    ds_write_b32 v65, v63 offset:11712
    s_mov_b64 exec, -1
    s_waitcnt lgkmcnt(0)
L_d_b9:
    s_barrier
    s_cmp_ge_u32 s52, 8
    s_cbranch_scc1 L_d_final
    v_lshlrev_b32 v4, 2, v0
    ds_read_b32 v8, v4 offset:10752
    ds_read_b32 v9, v4 offset:12800
    ds_read_b32 v10, v4 offset:14848
    ds_read_b32 v11, v4 offset:16896
    ds_read_b32 v12, v4 offset:18944
    ds_read_b32 v13, v4 offset:20992
    ds_read_b32 v14, v4 offset:23040
    ds_read_b32 v15, v4 offset:25088
    ds_read_b32 v16, v4 offset:27136
    v_and_b32 v76, 15, v74
    v_cmp_ne_u32 vcc, 8, v76
    s_cbranch_vccz L_d_hok
    buffer_load_dwordx2 v[74:75], v70, s[36:39], s68 offen sc1
    s_waitcnt vmcnt(0)
    s_nop 1
L_d_hok:
    s_waitcnt lgkmcnt(7)
    v_add_f32 v8, v8, v9
    s_waitcnt lgkmcnt(6)
    v_add_f32 v8, v8, v10
    s_waitcnt lgkmcnt(5)
    v_add_f32 v8, v8, v11
    s_waitcnt lgkmcnt(4)
    v_add_f32 v8, v8, v12
    s_waitcnt lgkmcnt(3)
    v_add_f32 v8, v8, v13
    s_waitcnt lgkmcnt(2)
    v_add_f32 v8, v8, v14
    s_waitcnt lgkmcnt(1)
    v_add_f32 v8, v8, v15
    s_waitcnt lgkmcnt(0)
    v_add_f32 v8, v8, v16
    v_floor_f32 v17, v8
    v_sub_f32 v8, v8, v17
    v_cvt_i32_f32 v21, v17
    v_mul_f32 v8, 0x4f800000, v8
    v_cvt_u32_f32 v8, v8
    v_and_or_b32 v20, v8, -16, 1
    v_mov_b32 v22, v20
    v_mov_b32 v23, v21
    buffer_atomic_add_x2 v[22:23], v70, s[36:39], s69 offen sc0 sc1
    v_lshlrev_b32 v72, 16, v72
    v_and_b32 v74, -16, v74
    v_cvt_f32_u32 v74, v74
    v_cvt_f32_i32 v75, v75
    v_fmac_f32 v75, 0x2f800000, v74
    v_cvt_pk_bf16_f32 v75, v75, v75
    v_lshlrev_b32 v75, 16, v75
    v_add_f32 v72, v72, v75
    v_cvt_pk_bf16_f32 v72, v72, v72
    v_lshlrev_b32 v72, 16, v72
    s_waitcnt vmcnt(0)
    v_add_co_u32 v22, vcc, v22, v20
    s_nop 1
    v_addc_co_u32 v23, vcc, v23, v21, vcc
    v_and_b32 v24, 15, v22
    v_and_b32 v22, -16, v22
    v_cvt_f32_u32 v22, v22
    v_cvt_f32_i32 v23, v23
    v_fmac_f32 v23, 0x2f800000, v22
    v_cvt_pk_bf16_f32 v23, v23, v23
    v_lshlrev_b32 v23, 16, v23
    v_add_f32 v72, v72, v23
    v_cvt_pk_bf16_f32 v72, v72, v72
    v_cmp_eq_u32 vcc, 8, v24
    s_and_saveexec_b64 s[70:71], vcc
    s_cbranch_execz L_d_nost
    buffer_store_short v72, v71, s[44:47], 0 offen
    s_nop 1
L_d_nost:
    s_mov_b64 exec, -1
    s_branch L_fin
L_d_final:
    s_cmp_lg_u32 s52, 9
    s_cbranch_scc1 L_fin
    s_cmp_lg_u32 s2, 0
    s_cbranch_scc1 L_fin
    v_mov_b32 v6, s67
    s_mov_b32 s57, 0xa2800
    s_mov_b64 exec, 1
    buffer_store_dword v6, v120, s[36:39], s57 offen sc1
    s_mov_b64 exec, -1
    s_branch L_fin
L_GU:
    s_sub_u32 s84, s2, 72
    s_barrier
    s_cmp_lt_u32 s52, 4
    s_cbranch_scc1 L_g_nodma
    s_lshl_b32 s59, s84, 6
    s_cmp_ge_u32 s52, 10
    s_cselect_b32 s57, s18, s16
    s_cselect_b32 s58, s19, s17
    s_cselect_b32 s60, 10, 4
    s_cselect_b32 s85, 36864, 0
    s_add_u32 s44, s57, s59
    s_addc_u32 s45, s58, 0
    s_mov_b32 s46, 5299264
    s_mov_b32 s47, 0x00020000
    s_sub_u32 s59, s52, s60
    s_mul_i32 s59, s59, 96
    s_add_u32 s85, s85, 29184
    v_lshrrev_b32 v4, 2, v1
    v_add_u32 v4, s59, v4
    v_mul_u32_u24 v4, 9216, v4
    v_and_b32 v5, 3, v1
    v_lshl_add_u32 v4, v5, 4, v4
    s_lshl_b32 s57, s59, 6
    s_add_u32 s57, s57, s85
    s_mov_b32 s58, 0
    s_mov_b32 m0, s57
    s_nop 0
    buffer_load_dwordx4 v4, s[44:47], s58 offen nt lds
    s_add_u32 s57, s57, 1024
    s_add_u32 s58, s58, 147456
    s_mov_b32 m0, s57
    s_nop 0
    buffer_load_dwordx4 v4, s[44:47], s58 offen nt lds
    s_add_u32 s57, s57, 1024
    s_add_u32 s58, s58, 147456
    s_mov_b32 m0, s57
    s_nop 0
    buffer_load_dwordx4 v4, s[44:47], s58 offen nt lds
    s_add_u32 s57, s57, 1024
    s_add_u32 s58, s58, 147456
    s_mov_b32 m0, s57
    s_nop 0
    buffer_load_dwordx4 v4, s[44:47], s58 offen nt lds
    s_add_u32 s57, s57, 1024
    s_add_u32 s58, s58, 147456
    s_mov_b32 m0, s57
    s_nop 0
    buffer_load_dwordx4 v4, s[44:47], s58 offen nt lds
    s_add_u32 s57, s57, 1024
    s_add_u32 s58, s58, 147456
    s_mov_b32 m0, s57
    s_nop 0
    buffer_load_dwordx4 v4, s[44:47], s58 offen nt lds
L_g_nodma:
    s_cmp_ge_u32 s52, 8
    s_cbranch_scc1 L_g_b8
    s_mul_i32 s57, s52, 1152
    s_add_u32 s40, s4, s57
    s_addc_u32 s41, s5, 0
    s_mov_b32 s42, 0x480
    s_mov_b32 s43, 0x00020000
    v_lshlrev_b32 v4, 1, v1
    buffer_load_ushort v8, v4, s[40:43], 0 offen offset:0
    buffer_load_ushort v9, v4, s[40:43], 0 offen offset:128
    buffer_load_ushort v10, v4, s[40:43], 0 offen offset:256
    buffer_load_ushort v11, v4, s[40:43], 0 offen offset:384
    buffer_load_ushort v12, v4, s[40:43], 0 offen offset:512
    buffer_load_ushort v13, v4, s[40:43], 0 offen offset:640
    buffer_load_ushort v14, v4, s[40:43], 0 offen offset:768
    buffer_load_ushort v15, v4, s[40:43], 0 offen offset:896
    buffer_load_ushort v16, v4, s[40:43], 0 offen offset:1024
    s_cmp_lg_u32 s52, 3
    s_cbranch_scc1 L_g_b8
    v_lshlrev_b32 v6, 9, v1
    s_mov_b32 s57, 0xb0000
    s_mov_b32 s58, 0xa2000
    s_mov_b32 s1, 0
    s_mov_b64 exec, 0x1ff
L_gpre:
    buffer_load_dword v41, v6, s[36:39], s57 offen sc1
    buffer_load_dword v42, v120, s[36:39], s58 offen sc1
    s_add_u32 s1, s1, 1
    s_waitcnt vmcnt(0)
    v_and_b32 v41, 15, v41
    v_cmp_eq_u32 vcc, s3, v42
    s_nop 1
    v_cndmask_b32 v41, 0, v41, vcc
    v_cmp_gt_u32 vcc, 6, v41
    s_cbranch_vccz L_gpre_ok
    s_sleep 2
    s_cmp_lt_u32 s1, 200000
    s_cbranch_scc1 L_gpre
    s_nop 0
L_gpre_ok:
    s_mov_b64 exec, -1
L_g_b8:
    v_and_b32 v61, 7, v1
    v_mul_u32_u24 v61, 1216, v61
    v_lshrrev_b32 v5, 4, v1
    v_lshl_add_u32 v61, v5, 4, v61
    v_bfe_u32 v62, v1, 2, 2
    v_lshl_add_u32 v62, v5, 3, v62
    v_lshlrev_b32 v62, 6, v62
    v_and_b32 v7, 3, v1
    v_lshl_add_u32 v62, v7, 3, v62
    s_lshr_b32 s57, s52, 2
    s_mul_i32 s58, s57, 384
    v_add_u32 v61, s58, v61
    s_mul_i32 s57, s57, 12288
    s_and_b32 s58, s52, 1
    s_lshl_b32 s58, s58, 5
    s_add_u32 s57, s57, s58
    s_bitcmp1_b32 s52, 1
    s_cselect_b32 s58, 36864, 0
    s_add_u32 s57, s57, s58
    s_add_u32 s57, s57, 29184
    v_add_u32 v62, s57, v62
    v_lshlrev_b32 v60, 8, v5
    v_and_b32 v7, 15, v1
    v_lshl_add_u32 v60, v7, 2, v60
    s_lshl_b32 s57, s52, 9
    v_add_u32 v60, s57, v60
    s_waitcnt vmcnt(0)
    s_barrier
    s_cmp_ge_u32 s52, 12
    s_cbranch_scc1 L_g_b9
    ds_read_b64_tr_b16 v[64:65], v62 offset:0
    ds_read_b64_tr_b16 v[66:67], v62 offset:256
    ds_read_b64_tr_b16 v[68:69], v62 offset:2048
    ds_read_b64_tr_b16 v[70:71], v62 offset:2304
    ds_read_b64_tr_b16 v[72:73], v62 offset:4096
    ds_read_b64_tr_b16 v[74:75], v62 offset:4352
    ds_read_b64_tr_b16 v[76:77], v62 offset:6144
    ds_read_b64_tr_b16 v[78:79], v62 offset:6400
    ds_read_b64_tr_b16 v[80:81], v62 offset:8192
    ds_read_b64_tr_b16 v[82:83], v62 offset:8448
    ds_read_b64_tr_b16 v[84:85], v62 offset:10240
    ds_read_b64_tr_b16 v[86:87], v62 offset:10496
    s_cmp_ge_u32 s52, 8
    s_cbranch_scc1 L_g_b9
    s_mul_i32 s57, s52, 4608
    s_add_u32 s57, s57, 0xb0000
    s_add_u32 s58, s57, 4096
    v_lshlrev_b32 v5, 3, v1
    s_mul_i32 s59, s52, 1216
    v_add_u32 v4, s59, v4
    s_mov_b32 s1, 0
    s_nop 0
L_g_ld:
    buffer_load_dwordx2 v[32:33], v5, s[36:39], s57 offen offset:0 sc1
    buffer_load_dwordx2 v[34:35], v5, s[36:39], s57 offen offset:512 sc1
    buffer_load_dwordx2 v[36:37], v5, s[36:39], s57 offen offset:1024 sc1
    buffer_load_dwordx2 v[38:39], v5, s[36:39], s57 offen offset:1536 sc1
    buffer_load_dwordx2 v[40:41], v5, s[36:39], s57 offen offset:2048 sc1
    buffer_load_dwordx2 v[42:43], v5, s[36:39], s57 offen offset:2560 sc1
    buffer_load_dwordx2 v[44:45], v5, s[36:39], s57 offen offset:3072 sc1
    buffer_load_dwordx2 v[46:47], v5, s[36:39], s57 offen offset:3584 sc1
    buffer_load_dwordx2 v[48:49], v5, s[36:39], s58 offen offset:0 sc1
    s_add_u32 s1, s1, 1
    s_waitcnt vmcnt(0)
    v_and_b32 v50, v32, v34
    v_or_b32 v51, v32, v34
    v_and_b32 v50, v50, v36
    v_or_b32 v51, v51, v36
    v_and_b32 v50, v50, v38
    v_or_b32 v51, v51, v38
    v_and_b32 v50, v50, v40
    v_or_b32 v51, v51, v40
    v_and_b32 v50, v50, v42
    v_or_b32 v51, v51, v42
    v_and_b32 v50, v50, v44
    v_or_b32 v51, v51, v44
    v_and_b32 v50, v50, v46
    v_or_b32 v51, v51, v46
    v_and_b32 v50, v50, v48
    v_or_b32 v51, v51, v48
    v_and_b32 v50, 8, v50
    v_and_or_b32 v50, v51, 7, v50
    v_cmp_ne_u32 vcc, 8, v50
    s_cbranch_vccz L_g_ld_ok
    s_sleep 1
    s_cmp_lt_u32 s1, 200000
    s_cbranch_scc1 L_g_ld
    s_nop 0
L_g_ld_ok:
    v_and_b32 v32, -16, v32
    v_cvt_f32_u32 v32, v32
    v_cvt_f32_i32 v33, v33
    v_fmac_f32 v33, 0x2f800000, v32
    v_lshlrev_b32 v8, 16, v8
    v_cvt_pk_bf16_f32 v33, v33, v33
    v_lshlrev_b32 v33, 16, v33
    v_add_f32 v8, v8, v33
    v_cvt_pk_bf16_f32 v8, v8, v8
    v_lshlrev_b32 v8, 16, v8
    v_and_b32 v34, -16, v34
    v_cvt_f32_u32 v34, v34
    v_cvt_f32_i32 v35, v35
    v_fmac_f32 v35, 0x2f800000, v34
    v_lshlrev_b32 v9, 16, v9
    v_cvt_pk_bf16_f32 v35, v35, v35
    v_lshlrev_b32 v35, 16, v35
    v_add_f32 v9, v9, v35
    v_cvt_pk_bf16_f32 v9, v9, v9
    v_lshlrev_b32 v9, 16, v9
    v_and_b32 v36, -16, v36
    v_cvt_f32_u32 v36, v36
    v_cvt_f32_i32 v37, v37
    v_fmac_f32 v37, 0x2f800000, v36
    v_lshlrev_b32 v10, 16, v10
    v_cvt_pk_bf16_f32 v37, v37, v37
    v_lshlrev_b32 v37, 16, v37
    v_add_f32 v10, v10, v37
    v_cvt_pk_bf16_f32 v10, v10, v10
    v_lshlrev_b32 v10, 16, v10
    v_and_b32 v38, -16, v38
    v_cvt_f32_u32 v38, v38
    v_cvt_f32_i32 v39, v39
    v_fmac_f32 v39, 0x2f800000, v38
    v_lshlrev_b32 v11, 16, v11
    v_cvt_pk_bf16_f32 v39, v39, v39
    v_lshlrev_b32 v39, 16, v39
    v_add_f32 v11, v11, v39
    v_cvt_pk_bf16_f32 v11, v11, v11
    v_lshlrev_b32 v11, 16, v11
    v_and_b32 v40, -16, v40
    v_cvt_f32_u32 v40, v40
    v_cvt_f32_i32 v41, v41
    v_fmac_f32 v41, 0x2f800000, v40
    v_lshlrev_b32 v12, 16, v12
    v_cvt_pk_bf16_f32 v41, v41, v41
    v_lshlrev_b32 v41, 16, v41
    v_add_f32 v12, v12, v41
    v_cvt_pk_bf16_f32 v12, v12, v12
    v_lshlrev_b32 v12, 16, v12
    v_and_b32 v42, -16, v42
    v_cvt_f32_u32 v42, v42
    v_cvt_f32_i32 v43, v43
    v_fmac_f32 v43, 0x2f800000, v42
    v_lshlrev_b32 v13, 16, v13
    v_cvt_pk_bf16_f32 v43, v43, v43
    v_lshlrev_b32 v43, 16, v43
    v_add_f32 v13, v13, v43
    v_cvt_pk_bf16_f32 v13, v13, v13
    v_lshlrev_b32 v13, 16, v13
    v_and_b32 v44, -16, v44
    v_cvt_f32_u32 v44, v44
    v_cvt_f32_i32 v45, v45
    v_fmac_f32 v45, 0x2f800000, v44
    v_lshlrev_b32 v14, 16, v14
    v_cvt_pk_bf16_f32 v45, v45, v45
    v_lshlrev_b32 v45, 16, v45
    v_add_f32 v14, v14, v45
    v_cvt_pk_bf16_f32 v14, v14, v14
    v_lshlrev_b32 v14, 16, v14
    v_and_b32 v46, -16, v46
    v_cvt_f32_u32 v46, v46
    v_cvt_f32_i32 v47, v47
    v_fmac_f32 v47, 0x2f800000, v46
    v_lshlrev_b32 v15, 16, v15
    v_cvt_pk_bf16_f32 v47, v47, v47
    v_lshlrev_b32 v47, 16, v47
    v_add_f32 v15, v15, v47
    v_cvt_pk_bf16_f32 v15, v15, v15
    v_lshlrev_b32 v15, 16, v15
    v_and_b32 v48, -16, v48
    v_cvt_f32_u32 v48, v48
    v_cvt_f32_i32 v49, v49
    v_fmac_f32 v49, 0x2f800000, v48
    v_lshlrev_b32 v16, 16, v16
    v_cvt_pk_bf16_f32 v49, v49, v49
    v_lshlrev_b32 v49, 16, v49
    v_add_f32 v16, v16, v49
    v_cvt_pk_bf16_f32 v16, v16, v16
    v_lshlrev_b32 v16, 16, v16
    v_add_f32 v26, v8, v9
    v_add_f32 v26, v26, v10
    v_add_f32 v26, v26, v11
    v_add_f32 v26, v26, v12
    v_add_f32 v26, v26, v13
    v_add_f32 v26, v26, v14
    v_add_f32 v26, v26, v15
    v_add_f32 v26, v26, v16
    s_nop 1
    v_add_f32_dpp v26, v26, v26 quad_perm:[1,0,3,2] row_mask:0xf bank_mask:0xf
    s_nop 1
    v_add_f32_dpp v26, v26, v26 quad_perm:[2,3,0,1] row_mask:0xf bank_mask:0xf
    s_nop 1
    v_add_f32_dpp v26, v26, v26 row_half_mirror row_mask:0xf bank_mask:0xf
    s_nop 1
    v_add_f32_dpp v26, v26, v26 row_mirror row_mask:0xf bank_mask:0xf
    v_mov_b32 v27, v26
    s_nop 1
    v_permlane16_swap_b32 v26, v27
    v_add_f32 v26, v26, v27
    v_mov_b32 v27, v26
    s_nop 1
    v_permlane32_swap_b32 v26, v27
    v_add_f32 v26, v26, v27
    v_mul_f32 v28, 0x3ae38e39, v26
    v_sub_f32 v27, v8, v28
    v_mul_f32 v26, v27, v27
    v_sub_f32 v27, v9, v28
    v_fmac_f32 v26, v27, v27
    v_sub_f32 v27, v10, v28
    v_fmac_f32 v26, v27, v27
    v_sub_f32 v27, v11, v28
    v_fmac_f32 v26, v27, v27
    v_sub_f32 v27, v12, v28
    v_fmac_f32 v26, v27, v27
    v_sub_f32 v27, v13, v28
    v_fmac_f32 v26, v27, v27
    v_sub_f32 v27, v14, v28
    v_fmac_f32 v26, v27, v27
    v_sub_f32 v27, v15, v28
    v_fmac_f32 v26, v27, v27
    v_sub_f32 v27, v16, v28
    v_fmac_f32 v26, v27, v27
    s_nop 1
    v_add_f32_dpp v26, v26, v26 quad_perm:[1,0,3,2] row_mask:0xf bank_mask:0xf
    s_nop 1
    v_add_f32_dpp v26, v26, v26 quad_perm:[2,3,0,1] row_mask:0xf bank_mask:0xf
    s_nop 1
    v_add_f32_dpp v26, v26, v26 row_half_mirror row_mask:0xf bank_mask:0xf
    s_nop 1
    v_add_f32_dpp v26, v26, v26 row_mirror row_mask:0xf bank_mask:0xf
    v_mov_b32 v27, v26
    s_nop 1
    v_permlane16_swap_b32 v26, v27
    v_add_f32 v26, v26, v27
    v_mov_b32 v27, v26
    s_nop 1
    v_permlane32_swap_b32 v26, v27
    v_add_f32 v26, v26, v27
    v_mul_f32 v26, 0x3ae38e39, v26
    v_cvt_pk_bf16_f32 v26, v26, v26
    v_lshlrev_b32 v26, 16, v26
    v_add_f32 v26, 0x3727c5ac, v26
    v_cvt_pk_bf16_f32 v26, v26, v26
    v_lshlrev_b32 v26, 16, v26
    v_sqrt_f32 v29, v26
    v_cvt_pk_bf16_f32 v28, v28, v28
    v_lshlrev_b32 v28, 16, v28
    v_rcp_f32 v30, v29
    v_fma_f32 v31, -v29, v29, v26
    v_mul_f32 v30, 0.5, v30
    v_fmac_f32 v29, v31, v30
    v_cvt_pk_bf16_f32 v29, v29, v29
    v_lshlrev_b32 v29, 16, v29
    v_rcp_f32 v30, v29
    v_sub_f32 v8, v8, v28
    v_cvt_pk_bf16_f32 v8, v8, v8
    v_lshlrev_b32 v8, 16, v8
    v_sub_f32 v9, v9, v28
    v_cvt_pk_bf16_f32 v9, v9, v9
    v_lshlrev_b32 v9, 16, v9
    v_sub_f32 v10, v10, v28
    v_cvt_pk_bf16_f32 v10, v10, v10
    v_lshlrev_b32 v10, 16, v10
    v_sub_f32 v11, v11, v28
    v_cvt_pk_bf16_f32 v11, v11, v11
    v_lshlrev_b32 v11, 16, v11
    v_sub_f32 v12, v12, v28
    v_cvt_pk_bf16_f32 v12, v12, v12
    v_lshlrev_b32 v12, 16, v12
    v_sub_f32 v13, v13, v28
    v_cvt_pk_bf16_f32 v13, v13, v13
    v_lshlrev_b32 v13, 16, v13
    v_sub_f32 v14, v14, v28
    v_cvt_pk_bf16_f32 v14, v14, v14
    v_lshlrev_b32 v14, 16, v14
    v_sub_f32 v15, v15, v28
    v_cvt_pk_bf16_f32 v15, v15, v15
    v_lshlrev_b32 v15, 16, v15
    v_sub_f32 v16, v16, v28
    v_cvt_pk_bf16_f32 v16, v16, v16
    v_lshlrev_b32 v16, 16, v16
    v_mul_f32 v27, v8, v30
    v_fma_f32 v31, -v27, v29, v8
    v_fma_f32 v8, v31, v30, v27
    v_mul_f32 v27, v9, v30
    v_fma_f32 v31, -v27, v29, v9
    v_fma_f32 v9, v31, v30, v27
    v_mul_f32 v27, v10, v30
    v_fma_f32 v31, -v27, v29, v10
    v_fma_f32 v10, v31, v30, v27
    v_mul_f32 v27, v11, v30
    v_fma_f32 v31, -v27, v29, v11
    v_fma_f32 v11, v31, v30, v27
    v_mul_f32 v27, v12, v30
    v_fma_f32 v31, -v27, v29, v12
    v_fma_f32 v12, v31, v30, v27
    v_mul_f32 v27, v13, v30
    v_fma_f32 v31, -v27, v29, v13
    v_fma_f32 v13, v31, v30, v27
    v_mul_f32 v27, v14, v30
    v_fma_f32 v31, -v27, v29, v14
    v_fma_f32 v14, v31, v30, v27
    v_mul_f32 v27, v15, v30
    v_fma_f32 v31, -v27, v29, v15
    v_fma_f32 v15, v31, v30, v27
    v_mul_f32 v27, v16, v30
    v_fma_f32 v31, -v27, v29, v16
    v_fma_f32 v16, v31, v30, v27
    v_cvt_pk_bf16_f32 v8, v8, v8
    ds_write_b16 v4, v8 offset:1024
    v_cvt_pk_bf16_f32 v9, v9, v9
    ds_write_b16 v4, v9 offset:1152
    v_cvt_pk_bf16_f32 v10, v10, v10
    ds_write_b16 v4, v10 offset:1280
    v_cvt_pk_bf16_f32 v11, v11, v11
    ds_write_b16 v4, v11 offset:1408
    v_cvt_pk_bf16_f32 v12, v12, v12
    ds_write_b16 v4, v12 offset:1536
    v_cvt_pk_bf16_f32 v13, v13, v13
    ds_write_b16 v4, v13 offset:1664
    v_cvt_pk_bf16_f32 v14, v14, v14
    ds_write_b16 v4, v14 offset:1792
    v_cvt_pk_bf16_f32 v15, v15, v15
    ds_write_b16 v4, v15 offset:1920
    v_cvt_pk_bf16_f32 v16, v16, v16
    ds_write_b16 v4, v16 offset:2048
    s_nop 0
L_g_b9:
    s_waitcnt vmcnt(0) lgkmcnt(0)
    s_barrier
    s_cmp_ge_u32 s52, 12
    s_cbranch_scc1 L_g_b10
    ds_read_b128 v[8:11], v61 offset:1024
    ds_read_b128 v[12:15], v61 offset:1088
    ds_read_b128 v[16:19], v61 offset:1152
    ds_read_b128 v[20:23], v61 offset:1216
    ds_read_b128 v[24:27], v61 offset:1280
    ds_read_b128 v[28:31], v61 offset:1344
    s_waitcnt lgkmcnt(5)
    v_mfma_f32_16x16x32_bf16 v[56:59], v[8:11], v[64:67], 0
    s_waitcnt lgkmcnt(4)
    v_mfma_f32_16x16x32_bf16 v[56:59], v[12:15], v[68:71], v[56:59]
    s_waitcnt lgkmcnt(3)
    v_mfma_f32_16x16x32_bf16 v[56:59], v[16:19], v[72:75], v[56:59]
    s_waitcnt lgkmcnt(2)
    v_mfma_f32_16x16x32_bf16 v[56:59], v[20:23], v[76:79], v[56:59]
    s_waitcnt lgkmcnt(1)
    v_mfma_f32_16x16x32_bf16 v[56:59], v[24:27], v[80:83], v[56:59]
    s_waitcnt lgkmcnt(0)
    v_mfma_f32_16x16x32_bf16 v[56:59], v[28:31], v[84:87], v[56:59]
    s_mov_b32 exec_lo, 0xffffffff
    s_mov_b32 exec_hi, 0x0
    s_nop 5
    ds_write_b32 v60, v56 offset:10752
    ds_write_b32 v60, v57 offset:10816
    ds_write_b32 v60, v58 offset:10880
    ds_write_b32 v60, v59 offset:10944
    s_mov_b64 exec, -1
    s_waitcnt lgkmcnt(0)
L_g_b10:
    s_barrier
    s_cmp_ge_u32 s52, 2
    s_cbranch_scc1 L_fin
    v_lshrrev_b32 v4, 4, v0
    v_bfe_u32 v5, v0, 3, 1
    v_lshlrev_b32 v5, 9, v5
    v_lshl_add_u32 v5, v4, 6, v5
    v_and_b32 v6, 7, v0
    v_lshl_add_u32 v5, v6, 3, v5
    ds_read_b64 v[8:9], v5 offset:10752
    ds_read_b64 v[14:15], v5 offset:11776
    ds_read_b64 v[10:11], v5 offset:12800
    ds_read_b64 v[16:17], v5 offset:13824
    ds_read_b64 v[12:13], v5 offset:14848
    ds_read_b64 v[18:19], v5 offset:15872
    v_mul_u32_u24 v4, 9216, v4
    v_and_b32 v6, 15, v0
    v_lshl_add_u32 v4, v6, 2, v4
    s_lshl_b32 s57, s84, 6
    s_add_u32 s57, s57, 0xd0000
    s_waitcnt lgkmcnt(0)
    v_add_f32 v8, v8, v10
    v_add_f32 v8, v8, v12
    v_add_f32 v14, v14, v16
    v_add_f32 v14, v14, v18
    v_cvt_pk_bf16_f32 v8, v8, v8
    v_lshlrev_b32 v8, 16, v8
    v_cvt_pk_bf16_f32 v14, v14, v14
    v_lshlrev_b32 v14, 16, v14
    v_mul_f32 v21, v8, v8
    v_mul_f32 v21, 0x3d372713, v21
    v_fma_f32 v20, v21, v8, v8
    v_mul_f32 v20, 0xc0135761, v20
    v_exp_f32 v20, v20
    s_nop 0
    v_add_f32 v20, 1.0, v20
    v_rcp_f32 v20, v20
    s_nop 0
    v_mul_f32 v8, v8, v20
    v_cvt_pk_bf16_f32 v8, v8, v8
    v_lshlrev_b32 v8, 16, v8
    v_mul_f32 v8, v8, v14
    v_add_f32 v9, v9, v11
    v_add_f32 v9, v9, v13
    v_add_f32 v15, v15, v17
    v_add_f32 v15, v15, v19
    v_cvt_pk_bf16_f32 v9, v9, v9
    v_lshlrev_b32 v9, 16, v9
    v_cvt_pk_bf16_f32 v15, v15, v15
    v_lshlrev_b32 v15, 16, v15
    v_mul_f32 v23, v9, v9
    v_mul_f32 v23, 0x3d372713, v23
    v_fma_f32 v22, v23, v9, v9
    v_mul_f32 v22, 0xc0135761, v22
    v_exp_f32 v22, v22
    s_nop 0
    v_add_f32 v22, 1.0, v22
    v_rcp_f32 v22, v22
    s_nop 0
    v_mul_f32 v9, v9, v22
    v_cvt_pk_bf16_f32 v9, v9, v9
    v_lshlrev_b32 v9, 16, v9
    v_mul_f32 v9, v9, v15
    v_cvt_pk_bf16_f32 v8, v8, v9
    buffer_store_dword v8, v4, s[36:39], s57 offen sc1
    s_nop 0
L_fin:
L_end:
    s_endpgm
.section .rodata,"a"
.p2align 6
.amdhsa_kernel sequential_preLN__gqa_block_cached__geglu_ffn__decode_kernel
  .amdhsa_next_free_vgpr 128
  .amdhsa_next_free_sgpr 86
  .amdhsa_accum_offset 128
  .amdhsa_group_segment_fixed_size 0
  .amdhsa_kernarg_size 96
  .amdhsa_user_sgpr_count 2
  .amdhsa_user_sgpr_kernarg_segment_ptr 1
  .amdhsa_system_sgpr_workgroup_id_x 1
  .amdhsa_float_denorm_mode_32 3
.end_amdhsa_kernel
```
